```python
import torch

def _softmax(x, axis=-1):
    return torch.softmax(x, dim=axis)
def _gelu(x):
    return torch.nn.functional.gelu(x, approximate="tanh")
def _silu(x):
    return torch.nn.functional.silu(x)
def _sigmoid(x):
    return torch.sigmoid(x)
def _layernorm(x, axis=-1, eps=1e-5):
    m = x.mean(dim=axis, keepdim=True)
    v = x.var(dim=axis, keepdim=True, unbiased=False)
    return (x - m) / torch.sqrt(v + eps)
def _scatter_add(tgt, idx, src, axis=0):
    return tgt.clone().index_add_(axis, idx, src)
def _segment_sum(src, seg, n):
    out = torch.zeros((n,) + src.shape[1:], dtype=src.dtype)
    return out.index_add_(0, seg, src)
def _pad(x, pw):
    flat = tuple(v for pair in reversed(pw) for v in pair)
    return torch.nn.functional.pad(x, flat)

kernel_name = 'gated_mix__softmax_full_mha__mixer_token_mlp__prompt'

def setup_inputs():

    _w = (lambda a: (lambda t: t.to(torch.bfloat16) if t.is_floating_point() else t)(torch.as_tensor(a)))
    def _A_setup():
        B, S, D = 1, 2048, 512
        return {
            "x": _w((lambda *s: torch.randn(*s, dtype=torch.bfloat16) * 0.05)(B, S, D)),
            "wqkv": _w((lambda *s: torch.randn(*s, dtype=torch.bfloat16) * 0.8)(D, 3 * D)),
            "wo": _w((lambda *s: torch.randn(*s, dtype=torch.bfloat16) * 0.05)(D, D)),
        }
    _A_in = _A_setup()

    def _B_setup():
        B, S, D, F = 1, 2048, 512, 1376
        return {
            "x": _w((lambda *s: torch.randn(*s, dtype=torch.bfloat16) * 0.05)(B, S, D)),
            "w1": _w((lambda *s: torch.randn(*s, dtype=torch.bfloat16) * 0.8)(S, F) * (S ** -0.5)),
            "b1": _w((lambda *s: torch.randn(*s, dtype=torch.bfloat16) * 12.8)(F) * 0.02),
            "w2": _w((lambda *s: torch.randn(*s, dtype=torch.bfloat16) * 0.05)(F, S) * (F ** -0.5)),
            "b2": _w((lambda *s: torch.randn(*s, dtype=torch.bfloat16) * 0.8)(S) * 0.02),
        }
    _B_in = _B_setup()

    return {
        "A_x": _A_in["x"],
        "A_wqkv": _A_in["wqkv"],
        "A_wo": _A_in["wo"],
        "B_x": _B_in["x"],
        "B_w1": _B_in["w1"],
        "B_b1": _B_in["b1"],
        "B_w2": _B_in["w2"],
        "B_b2": _B_in["b2"],
        "gate_w": _w((lambda *s: torch.randn(*s, dtype=torch.bfloat16) * 0.05)(512) * 16.0),
    }

def reference(A_x, A_wqkv, A_wo, B_x, B_w1, B_b1, B_w2, B_b2, gate_w):
    def _A_ref(x, wqkv, wo):
        B, S, D = x.shape
        H = 32; Dh = D // H
        qkv = (lambda x, *d: x.permute(*d))((x @ wqkv).reshape(B, S, 3, H, Dh), 2, 0, 3, 1, 4)
        q, k, v = qkv[0], qkv[1], qkv[2]
        scale = Dh ** -0.5
        scores = torch.einsum("bhqd,bhkd->bhqk", q, k) * scale
        p = _softmax(scores, axis=-1)
        o = torch.einsum("bhqk,bhkd->bhqd", p, v)
        return (lambda x, *d: x.permute(*d))(o, 0, 2, 1, 3).reshape(B, S, D) @ wo

    def _B_ref(x, w1, b1, w2, b2):
        B, S, D = x.shape
        h = _layernorm(x, axis=-1)
        u = torch.einsum("bsd,sf->bdf", h, w1) + b1
        u = _gelu(u)
        y = torch.einsum("bdf,fs->bds", u, w2) + b2
        return (lambda x, *d: x.permute(*d))(y, 0, 2, 1)

    x = A_x
    g = _sigmoid((x * gate_w).sum(-1, keepdims=True))
    a = _A_ref(x, A_wqkv, A_wo)
    b = _B_ref(x, B_w1, B_b1, B_w2, B_b2)
    return g * a + (1 - g) * b
```

```asm
; @launch grid=(256,1,1) block=(768,1,1) lds=163840
.amdgcn_target "amdgcn-amd-amdhsa--gfx950"
.text
.globl gated_mix__softmax_full_mha__mixer_token_mlp__prompt_kernel
.p2align 8
.type gated_mix__softmax_full_mha__mixer_token_mlp__prompt_kernel,@function
gated_mix__softmax_full_mha__mixer_token_mlp__prompt_kernel:
    s_cmp_ge_u32 s2, 256
    s_cbranch_scc1 L_end
    s_load_dwordx16 s[36:51], s[0:1], 0
    s_load_dwordx8 s[52:59], s[0:1], 64
    v_lshrrev_b32 v1, 6, v0
    v_and_b32 v2, 63, v0
    v_readfirstlane_b32 s3, v1
    s_and_b32 s24, s2, 7
    s_lshr_b32 s25, s2, 3
    s_cmp_lg_u32 s3, 11
    s_cbranch_scc1 L_nopf
    s_getpc_b64 s[4:5]
L_pc:
    v_lshlrev_b32 v136, 7, v2
    global_load_dword v137, v136, s[4:5]
    v_add_u32 v136, 8192, v136
    global_load_dword v137, v136, s[4:5]
    v_add_u32 v136, 8192, v136
    v_min_u32 v136, L_end-L_pc-4, v136
    global_load_dword v137, v136, s[4:5]
L_nopf:
    s_cmp_ge_u32 s3, 8
    s_cbranch_scc1 L_m_start
    s_cmp_ge_u32 s25, 24
    s_cbranch_scc1 L_ln
    s_lshr_b32 s26, s24, 1
    s_lshl_b32 s26, s26, 2
    s_and_b32 s6, s25, 3
    s_add_u32 s26, s26, s6
    s_and_b32 s27, s24, 1
    s_mul_i32 s27, s27, 6
    s_lshr_b32 s7, s25, 2
    s_add_u32 s27, s27, s7
    s_cmp_lt_u32 s3, 4
    s_cbranch_scc1 L_comp
    s_sub_u32 s33, s3, 4
    s_lshl_b32 s28, s26, 17
    s_lshl_b32 s29, s33, 15
    s_add_u32 s28, s28, s29
    s_mul_i32 s29, s33, 49152
    s_lshl_b32 s30, s27, 8
    s_add_u32 s29, s29, s30
    s_lshl_b32 s30, s33, 12
    v_lshrrev_b32 v3, 3, v2
    v_lshlrev_b32 v3, 10, v3
    v_lshrrev_b32 v4, 4, v2
    v_and_b32 v5, 7, v2
    v_xor_b32 v5, v5, v4
    v_lshl_add_u32 v3, v5, 4, v3
    v_xor_b32 v6, 64, v3
    v_mul_u32_u24 v7, 3072, v4
    v_and_b32 v5, 15, v2
    v_lshlrev_b32 v8, 2, v4
    v_xor_b32 v5, v5, v8
    v_lshl_add_u32 v7, v5, 4, v7
    s_lshl_b32 s8, s6, 1
    s_add_u32 s8, s8, s7
    s_add_u32 s4, s7, s6
    s_cmp_lt_u32 4, 8
    s_cselect_b32 s8, s4, s8
    s_and_b32 s34, s8, 3
    s_mov_b32 s9, 0
    s_waitcnt lgkmcnt(0)
    s_mov_b32 s12, s36
    s_and_b32 s13, s37, 0xffff
    s_mov_b32 s14, 0x200000
    s_mov_b32 s15, 0x00020000
    s_mov_b32 s16, s38
    s_and_b32 s17, s39, 0xffff
    s_mov_b32 s18, 0x180000
    s_mov_b32 s19, 0x00020000
L_ld:
    s_cmp_lt_u32 s9, 2
    s_cbranch_scc1 L_ld_issue
    s_cmp_eq_u32 s9, 3
    s_cbranch_scc1 L_ld_issue
    s_cmp_eq_u32 s9, 2
    s_cbranch_scc0 L_ld_w16
    s_waitcnt vmcnt(8)
L_ld_w16:
    s_waitcnt vmcnt(16)
    s_barrier
L_ld_issue:
    s_xor_b32 s8, s9, s34
    s_lshl_b32 s10, s8, 7
    s_add_u32 s10, s10, s28
    s_mul_i32 s11, s8, 196608
    s_add_u32 s11, s11, s29
    s_add_u32 m0, s30, 0
    s_add_u32 s31, s10, 0
    buffer_load_dwordx4 v3, s[12:15], s31 offen lds
    s_add_u32 m0, s30, 16384
    s_add_u32 s31, s11, 0
    buffer_load_dwordx4 v7, s[16:19], s31 offen lds
    s_add_u32 m0, s30, 1024
    s_add_u32 s31, s10, 8192
    buffer_load_dwordx4 v6, s[12:15], s31 offen lds
    s_add_u32 m0, s30, 17408
    s_add_u32 s31, s11, 12288
    buffer_load_dwordx4 v7, s[16:19], s31 offen lds
    s_add_u32 m0, s30, 2048
    s_add_u32 s31, s10, 16384
    buffer_load_dwordx4 v3, s[12:15], s31 offen lds
    s_add_u32 m0, s30, 18432
    s_add_u32 s31, s11, 24576
    buffer_load_dwordx4 v7, s[16:19], s31 offen lds
    s_add_u32 m0, s30, 3072
    s_add_u32 s31, s10, 24576
    buffer_load_dwordx4 v6, s[12:15], s31 offen lds
    s_add_u32 m0, s30, 19456
    s_add_u32 s31, s11, 36864
    buffer_load_dwordx4 v7, s[16:19], s31 offen lds
    s_add_u32 s30, s30, 32768
    s_and_b32 s30, s30, 0x1ffff
    s_add_u32 s9, s9, 1
    s_cmp_lt_u32 s9, 8
    s_cbranch_scc1 L_ld
    s_mov_b32 s20, s58
    s_and_b32 s21, s59, 0xffff
    s_mov_b32 s22, 0x10000000
    s_mov_b32 s23, 0x00020000
    s_waitcnt vmcnt(16)
    s_barrier
    s_waitcnt vmcnt(8)
    s_barrier
    s_waitcnt vmcnt(0)
    s_barrier
    s_barrier
    s_branch L_attn
L_ln:
    s_lshl_b32 s28, s24, 3
    s_add_u32 s28, s28, s25
    s_sub_u32 s28, s28, 24
    s_lshl_b32 s29, s28, 5
    s_lshl_b32 s4, s3, 2
    s_add_u32 s29, s29, s4
    s_lshl_b32 s31, s29, 10
    v_lshlrev_b32 v14, 4, v2
    v_mov_b32 v15, 0
    s_mov_b32 s10, 0xffff0000
    s_waitcnt lgkmcnt(0)
    s_mov_b32 s12, s36
    s_and_b32 s13, s37, 0xffff
    s_mov_b32 s14, 0x200000
    s_mov_b32 s15, 0x00020000
    s_mov_b32 s16, s52
    s_and_b32 s17, s53, 0xffff
    s_mov_b32 s18, 0x400
    s_mov_b32 s19, 0x00020000
    buffer_load_dwordx4 v[16:19], v14, s[12:15], s31 offen offset:0
    buffer_load_dwordx4 v[20:23], v14, s[12:15], s31 offen offset:1024
    buffer_load_dwordx4 v[24:27], v14, s[12:15], s31 offen offset:2048
    buffer_load_dwordx4 v[28:31], v14, s[12:15], s31 offen offset:3072
    buffer_load_dwordx4 v[32:35], v14, s[16:19], 0 offen
    s_mov_b32 s20, s58
    s_and_b32 s21, s59, 0xffff
    s_mov_b32 s22, 0x10000000
    s_mov_b32 s23, 0x00020000
    s_waitcnt vmcnt(0)
    v_lshlrev_b32 v72, 16, v32
    v_and_b32 v73, s10, v32
    v_lshlrev_b32 v74, 16, v33
    v_and_b32 v75, s10, v33
    v_lshlrev_b32 v76, 16, v34
    v_and_b32 v77, s10, v34
    v_lshlrev_b32 v78, 16, v35
    v_and_b32 v79, s10, v35
    v_lshlrev_b32 v40, 16, v16
    v_and_b32 v41, s10, v16
    v_lshlrev_b32 v42, 16, v17
    v_and_b32 v43, s10, v17
    v_lshlrev_b32 v44, 16, v18
    v_and_b32 v45, s10, v18
    v_lshlrev_b32 v46, 16, v19
    v_and_b32 v47, s10, v19
    v_lshlrev_b32 v48, 16, v20
    v_and_b32 v49, s10, v20
    v_lshlrev_b32 v50, 16, v21
    v_and_b32 v51, s10, v21
    v_lshlrev_b32 v52, 16, v22
    v_and_b32 v53, s10, v22
    v_lshlrev_b32 v54, 16, v23
    v_and_b32 v55, s10, v23
    v_lshlrev_b32 v56, 16, v24
    v_and_b32 v57, s10, v24
    v_lshlrev_b32 v58, 16, v25
    v_and_b32 v59, s10, v25
    v_lshlrev_b32 v60, 16, v26
    v_and_b32 v61, s10, v26
    v_lshlrev_b32 v62, 16, v27
    v_and_b32 v63, s10, v27
    v_lshlrev_b32 v64, 16, v28
    v_and_b32 v65, s10, v28
    v_lshlrev_b32 v66, 16, v29
    v_and_b32 v67, s10, v29
    v_lshlrev_b32 v68, 16, v30
    v_and_b32 v69, s10, v30
    v_lshlrev_b32 v70, 16, v31
    v_and_b32 v71, s10, v31
    v_add_f32 v80, v40, v41
    v_mul_f32 v84, v40, v72
    v_add_f32 v81, v48, v49
    v_mul_f32 v85, v48, v72
    v_add_f32 v82, v56, v57
    v_mul_f32 v86, v56, v72
    v_add_f32 v83, v64, v65
    v_mul_f32 v87, v64, v72
    v_fmac_f32 v84, v41, v73
    v_fmac_f32 v85, v49, v73
    v_fmac_f32 v86, v57, v73
    v_fmac_f32 v87, v65, v73
    v_add_f32 v80, v80, v42
    v_fmac_f32 v84, v42, v74
    v_add_f32 v81, v81, v50
    v_fmac_f32 v85, v50, v74
    v_add_f32 v82, v82, v58
    v_fmac_f32 v86, v58, v74
    v_add_f32 v83, v83, v66
    v_fmac_f32 v87, v66, v74
    v_add_f32 v80, v80, v43
    v_fmac_f32 v84, v43, v75
    v_add_f32 v81, v81, v51
    v_fmac_f32 v85, v51, v75
    v_add_f32 v82, v82, v59
    v_fmac_f32 v86, v59, v75
    v_add_f32 v83, v83, v67
    v_fmac_f32 v87, v67, v75
    v_add_f32 v80, v80, v44
    v_fmac_f32 v84, v44, v76
    v_add_f32 v81, v81, v52
    v_fmac_f32 v85, v52, v76
    v_add_f32 v82, v82, v60
    v_fmac_f32 v86, v60, v76
    v_add_f32 v83, v83, v68
    v_fmac_f32 v87, v68, v76
    v_add_f32 v80, v80, v45
    v_fmac_f32 v84, v45, v77
    v_add_f32 v81, v81, v53
    v_fmac_f32 v85, v53, v77
    v_add_f32 v82, v82, v61
    v_fmac_f32 v86, v61, v77
    v_add_f32 v83, v83, v69
    v_fmac_f32 v87, v69, v77
    v_add_f32 v80, v80, v46
    v_fmac_f32 v84, v46, v78
    v_add_f32 v81, v81, v54
    v_fmac_f32 v85, v54, v78
    v_add_f32 v82, v82, v62
    v_fmac_f32 v86, v62, v78
    v_add_f32 v83, v83, v70
    v_fmac_f32 v87, v70, v78
    v_add_f32 v80, v80, v47
    v_fmac_f32 v84, v47, v79
    v_add_f32 v81, v81, v55
    v_fmac_f32 v85, v55, v79
    v_add_f32 v82, v82, v63
    v_fmac_f32 v86, v63, v79
    v_add_f32 v83, v83, v71
    v_fmac_f32 v87, v71, v79
    s_nop 1
    v_add_f32_dpp v80, v80, v80 row_shr:1 row_mask:0xf bank_mask:0xf bound_ctrl:0
    v_add_f32_dpp v81, v81, v81 row_shr:1 row_mask:0xf bank_mask:0xf bound_ctrl:0
    v_add_f32_dpp v82, v82, v82 row_shr:1 row_mask:0xf bank_mask:0xf bound_ctrl:0
    v_add_f32_dpp v83, v83, v83 row_shr:1 row_mask:0xf bank_mask:0xf bound_ctrl:0
    v_add_f32_dpp v84, v84, v84 row_shr:1 row_mask:0xf bank_mask:0xf bound_ctrl:0
    v_add_f32_dpp v85, v85, v85 row_shr:1 row_mask:0xf bank_mask:0xf bound_ctrl:0
    v_add_f32_dpp v86, v86, v86 row_shr:1 row_mask:0xf bank_mask:0xf bound_ctrl:0
    v_add_f32_dpp v87, v87, v87 row_shr:1 row_mask:0xf bank_mask:0xf bound_ctrl:0
    v_add_f32_dpp v80, v80, v80 row_shr:2 row_mask:0xf bank_mask:0xf bound_ctrl:0
    v_add_f32_dpp v81, v81, v81 row_shr:2 row_mask:0xf bank_mask:0xf bound_ctrl:0
    v_add_f32_dpp v82, v82, v82 row_shr:2 row_mask:0xf bank_mask:0xf bound_ctrl:0
    v_add_f32_dpp v83, v83, v83 row_shr:2 row_mask:0xf bank_mask:0xf bound_ctrl:0
    v_add_f32_dpp v84, v84, v84 row_shr:2 row_mask:0xf bank_mask:0xf bound_ctrl:0
    v_add_f32_dpp v85, v85, v85 row_shr:2 row_mask:0xf bank_mask:0xf bound_ctrl:0
    v_add_f32_dpp v86, v86, v86 row_shr:2 row_mask:0xf bank_mask:0xf bound_ctrl:0
    v_add_f32_dpp v87, v87, v87 row_shr:2 row_mask:0xf bank_mask:0xf bound_ctrl:0
    v_add_f32_dpp v80, v80, v80 row_shr:4 row_mask:0xf bank_mask:0xf bound_ctrl:0
    v_add_f32_dpp v81, v81, v81 row_shr:4 row_mask:0xf bank_mask:0xf bound_ctrl:0
    v_add_f32_dpp v82, v82, v82 row_shr:4 row_mask:0xf bank_mask:0xf bound_ctrl:0
    v_add_f32_dpp v83, v83, v83 row_shr:4 row_mask:0xf bank_mask:0xf bound_ctrl:0
    v_add_f32_dpp v84, v84, v84 row_shr:4 row_mask:0xf bank_mask:0xf bound_ctrl:0
    v_add_f32_dpp v85, v85, v85 row_shr:4 row_mask:0xf bank_mask:0xf bound_ctrl:0
    v_add_f32_dpp v86, v86, v86 row_shr:4 row_mask:0xf bank_mask:0xf bound_ctrl:0
    v_add_f32_dpp v87, v87, v87 row_shr:4 row_mask:0xf bank_mask:0xf bound_ctrl:0
    v_add_f32_dpp v80, v80, v80 row_shr:8 row_mask:0xf bank_mask:0xf bound_ctrl:0
    v_add_f32_dpp v81, v81, v81 row_shr:8 row_mask:0xf bank_mask:0xf bound_ctrl:0
    v_add_f32_dpp v82, v82, v82 row_shr:8 row_mask:0xf bank_mask:0xf bound_ctrl:0
    v_add_f32_dpp v83, v83, v83 row_shr:8 row_mask:0xf bank_mask:0xf bound_ctrl:0
    v_add_f32_dpp v84, v84, v84 row_shr:8 row_mask:0xf bank_mask:0xf bound_ctrl:0
    v_add_f32_dpp v85, v85, v85 row_shr:8 row_mask:0xf bank_mask:0xf bound_ctrl:0
    v_add_f32_dpp v86, v86, v86 row_shr:8 row_mask:0xf bank_mask:0xf bound_ctrl:0
    v_add_f32_dpp v87, v87, v87 row_shr:8 row_mask:0xf bank_mask:0xf bound_ctrl:0
    v_add_f32_dpp v80, v80, v80 row_bcast:15 row_mask:0xa bank_mask:0xf
    v_add_f32_dpp v81, v81, v81 row_bcast:15 row_mask:0xa bank_mask:0xf
    v_add_f32_dpp v82, v82, v82 row_bcast:15 row_mask:0xa bank_mask:0xf
    v_add_f32_dpp v83, v83, v83 row_bcast:15 row_mask:0xa bank_mask:0xf
    v_add_f32_dpp v84, v84, v84 row_bcast:15 row_mask:0xa bank_mask:0xf
    v_add_f32_dpp v85, v85, v85 row_bcast:15 row_mask:0xa bank_mask:0xf
    v_add_f32_dpp v86, v86, v86 row_bcast:15 row_mask:0xa bank_mask:0xf
    v_add_f32_dpp v87, v87, v87 row_bcast:15 row_mask:0xa bank_mask:0xf
    v_add_f32_dpp v80, v80, v80 row_bcast:31 row_mask:0xc bank_mask:0xf
    v_add_f32_dpp v81, v81, v81 row_bcast:31 row_mask:0xc bank_mask:0xf
    v_add_f32_dpp v82, v82, v82 row_bcast:31 row_mask:0xc bank_mask:0xf
    v_add_f32_dpp v83, v83, v83 row_bcast:31 row_mask:0xc bank_mask:0xf
    v_add_f32_dpp v84, v84, v84 row_bcast:31 row_mask:0xc bank_mask:0xf
    v_add_f32_dpp v85, v85, v85 row_bcast:31 row_mask:0xc bank_mask:0xf
    v_add_f32_dpp v86, v86, v86 row_bcast:31 row_mask:0xc bank_mask:0xf
    v_add_f32_dpp v87, v87, v87 row_bcast:31 row_mask:0xc bank_mask:0xf
    s_mov_b32 s10, 0x3b000000
    s_mov_b32 s11, 0xbfb8aa3b
    v_mul_f32 v80, s10, v80
    v_mul_f32 v81, s10, v81
    v_mul_f32 v82, s10, v82
    v_mul_f32 v83, s10, v83
    v_mul_f32 v84, s11, v84
    v_mul_f32 v85, s11, v85
    v_mul_f32 v86, s11, v86
    v_mul_f32 v87, s11, v87
    v_readlane_b32 s4, v80, 63
    v_readlane_b32 s5, v81, 63
    v_readlane_b32 s6, v82, 63
    v_readlane_b32 s7, v83, 63
    v_exp_f32 v84, v84
    v_exp_f32 v85, v85
    v_exp_f32 v86, v86
    v_exp_f32 v87, v87
    v_subrev_f32 v40, s4, v40
    v_subrev_f32 v41, s4, v41
    v_subrev_f32 v42, s4, v42
    v_subrev_f32 v43, s4, v43
    v_subrev_f32 v44, s4, v44
    v_subrev_f32 v45, s4, v45
    v_subrev_f32 v46, s4, v46
    v_subrev_f32 v47, s4, v47
    v_subrev_f32 v48, s5, v48
    v_subrev_f32 v49, s5, v49
    v_subrev_f32 v50, s5, v50
    v_subrev_f32 v51, s5, v51
    v_subrev_f32 v52, s5, v52
    v_subrev_f32 v53, s5, v53
    v_subrev_f32 v54, s5, v54
    v_subrev_f32 v55, s5, v55
    v_subrev_f32 v56, s6, v56
    v_subrev_f32 v57, s6, v57
    v_subrev_f32 v58, s6, v58
    v_subrev_f32 v59, s6, v59
    v_subrev_f32 v60, s6, v60
    v_subrev_f32 v61, s6, v61
    v_subrev_f32 v62, s6, v62
    v_subrev_f32 v63, s6, v63
    v_subrev_f32 v64, s7, v64
    v_subrev_f32 v65, s7, v65
    v_subrev_f32 v66, s7, v66
    v_subrev_f32 v67, s7, v67
    v_subrev_f32 v68, s7, v68
    v_subrev_f32 v69, s7, v69
    v_subrev_f32 v70, s7, v70
    v_subrev_f32 v71, s7, v71
    v_add_f32 v84, 1.0, v84
    v_add_f32 v85, 1.0, v85
    v_add_f32 v86, 1.0, v86
    v_add_f32 v87, 1.0, v87
    v_rcp_f32 v84, v84
    v_rcp_f32 v85, v85
    v_rcp_f32 v86, v86
    v_rcp_f32 v87, v87
    v_mul_f32 v80, v40, v40
    v_mul_f32 v81, v48, v48
    v_mul_f32 v82, v56, v56
    v_mul_f32 v83, v64, v64
    v_fmac_f32 v80, v41, v41
    v_fmac_f32 v81, v49, v49
    v_fmac_f32 v82, v57, v57
    v_fmac_f32 v83, v65, v65
    v_fmac_f32 v80, v42, v42
    v_fmac_f32 v81, v50, v50
    v_fmac_f32 v82, v58, v58
    v_fmac_f32 v83, v66, v66
    v_fmac_f32 v80, v43, v43
    v_fmac_f32 v81, v51, v51
    v_fmac_f32 v82, v59, v59
    v_fmac_f32 v83, v67, v67
    v_fmac_f32 v80, v44, v44
    v_fmac_f32 v81, v52, v52
    v_fmac_f32 v82, v60, v60
    v_fmac_f32 v83, v68, v68
    v_fmac_f32 v80, v45, v45
    v_fmac_f32 v81, v53, v53
    v_fmac_f32 v82, v61, v61
    v_fmac_f32 v83, v69, v69
    v_fmac_f32 v80, v46, v46
    v_fmac_f32 v81, v54, v54
    v_fmac_f32 v82, v62, v62
    v_fmac_f32 v83, v70, v70
    v_fmac_f32 v80, v47, v47
    v_fmac_f32 v81, v55, v55
    v_fmac_f32 v82, v63, v63
    v_fmac_f32 v83, v71, v71
    s_nop 1
    v_add_f32_dpp v80, v80, v80 row_shr:1 row_mask:0xf bank_mask:0xf bound_ctrl:0
    v_add_f32_dpp v81, v81, v81 row_shr:1 row_mask:0xf bank_mask:0xf bound_ctrl:0
    v_add_f32_dpp v82, v82, v82 row_shr:1 row_mask:0xf bank_mask:0xf bound_ctrl:0
    v_add_f32_dpp v83, v83, v83 row_shr:1 row_mask:0xf bank_mask:0xf bound_ctrl:0
    v_add_f32_dpp v80, v80, v80 row_shr:2 row_mask:0xf bank_mask:0xf bound_ctrl:0
    v_add_f32_dpp v81, v81, v81 row_shr:2 row_mask:0xf bank_mask:0xf bound_ctrl:0
    v_add_f32_dpp v82, v82, v82 row_shr:2 row_mask:0xf bank_mask:0xf bound_ctrl:0
    v_add_f32_dpp v83, v83, v83 row_shr:2 row_mask:0xf bank_mask:0xf bound_ctrl:0
    v_add_f32_dpp v80, v80, v80 row_shr:4 row_mask:0xf bank_mask:0xf bound_ctrl:0
    v_add_f32_dpp v81, v81, v81 row_shr:4 row_mask:0xf bank_mask:0xf bound_ctrl:0
    v_add_f32_dpp v82, v82, v82 row_shr:4 row_mask:0xf bank_mask:0xf bound_ctrl:0
    v_add_f32_dpp v83, v83, v83 row_shr:4 row_mask:0xf bank_mask:0xf bound_ctrl:0
    v_add_f32_dpp v80, v80, v80 row_shr:8 row_mask:0xf bank_mask:0xf bound_ctrl:0
    v_add_f32_dpp v81, v81, v81 row_shr:8 row_mask:0xf bank_mask:0xf bound_ctrl:0
    v_add_f32_dpp v82, v82, v82 row_shr:8 row_mask:0xf bank_mask:0xf bound_ctrl:0
    v_add_f32_dpp v83, v83, v83 row_shr:8 row_mask:0xf bank_mask:0xf bound_ctrl:0
    v_add_f32_dpp v80, v80, v80 row_bcast:15 row_mask:0xa bank_mask:0xf
    v_add_f32_dpp v81, v81, v81 row_bcast:15 row_mask:0xa bank_mask:0xf
    v_add_f32_dpp v82, v82, v82 row_bcast:15 row_mask:0xa bank_mask:0xf
    v_add_f32_dpp v83, v83, v83 row_bcast:15 row_mask:0xa bank_mask:0xf
    v_add_f32_dpp v80, v80, v80 row_bcast:31 row_mask:0xc bank_mask:0xf
    v_add_f32_dpp v81, v81, v81 row_bcast:31 row_mask:0xc bank_mask:0xf
    v_add_f32_dpp v82, v82, v82 row_bcast:31 row_mask:0xc bank_mask:0xf
    v_add_f32_dpp v83, v83, v83 row_bcast:31 row_mask:0xc bank_mask:0xf
    v_mov_b32 v88, 0x3727c5ac
    v_fma_f32 v80, v80, s10, v88
    v_fma_f32 v81, v81, s10, v88
    v_fma_f32 v82, v82, s10, v88
    v_fma_f32 v83, v83, s10, v88
    v_rsq_f32 v80, v80
    v_rsq_f32 v81, v81
    v_rsq_f32 v82, v82
    v_rsq_f32 v83, v83
    s_nop 0
    v_readlane_b32 s4, v80, 63
    v_readlane_b32 s5, v81, 63
    v_readlane_b32 s6, v82, 63
    v_readlane_b32 s7, v83, 63
    s_lshl_b32 s31, s29, 2
    s_add_u32 s31, s31, 9961472
    s_mov_b32 exec_lo, 0
    s_mov_b32 exec_hi, 0x80000000
    buffer_store_dwordx4 v[84:87], v15, s[20:23], s31 offen sc1
    s_mov_b64 exec, -1
    s_lshl_b32 s31, s3, 12
    v_lshlrev_b32 v10, 5, v2
    v_add_u32 v10, s31, v10
    v_mul_f32 v40, s4, v40
    v_mul_f32 v41, s4, v41
    v_mul_f32 v42, s4, v42
    v_mul_f32 v43, s4, v43
    v_mul_f32 v44, s4, v44
    v_mul_f32 v45, s4, v45
    v_mul_f32 v46, s4, v46
    v_mul_f32 v47, s4, v47
    v_mul_f32 v48, s5, v48
    v_mul_f32 v49, s5, v49
    v_mul_f32 v50, s5, v50
    v_mul_f32 v51, s5, v51
    v_mul_f32 v52, s5, v52
    v_mul_f32 v53, s5, v53
    v_mul_f32 v54, s5, v54
    v_mul_f32 v55, s5, v55
    v_mul_f32 v56, s6, v56
    v_mul_f32 v57, s6, v57
    v_mul_f32 v58, s6, v58
    v_mul_f32 v59, s6, v59
    v_mul_f32 v60, s6, v60
    v_mul_f32 v61, s6, v61
    v_mul_f32 v62, s6, v62
    v_mul_f32 v63, s6, v63
    v_mul_f32 v64, s7, v64
    v_mul_f32 v65, s7, v65
    v_mul_f32 v66, s7, v66
    v_mul_f32 v67, s7, v67
    v_mul_f32 v68, s7, v68
    v_mul_f32 v69, s7, v69
    v_mul_f32 v70, s7, v70
    v_mul_f32 v71, s7, v71
    v_cvt_pk_bf16_f32 v88, v40, v48
    v_cvt_pk_bf16_f32 v89, v41, v49
    v_cvt_pk_bf16_f32 v90, v42, v50
    v_cvt_pk_bf16_f32 v91, v43, v51
    v_cvt_pk_bf16_f32 v92, v44, v52
    v_cvt_pk_bf16_f32 v93, v45, v53
    v_cvt_pk_bf16_f32 v94, v46, v54
    v_cvt_pk_bf16_f32 v95, v47, v55
    ds_write_b128 v10, v[88:91] offset:0
    ds_write_b128 v10, v[92:95] offset:16
    v_cvt_pk_bf16_f32 v96, v56, v64
    v_cvt_pk_bf16_f32 v97, v57, v65
    v_cvt_pk_bf16_f32 v98, v58, v66
    v_cvt_pk_bf16_f32 v99, v59, v67
    v_cvt_pk_bf16_f32 v100, v60, v68
    v_cvt_pk_bf16_f32 v101, v61, v69
    v_cvt_pk_bf16_f32 v102, v62, v70
    v_cvt_pk_bf16_f32 v103, v63, v71
    ds_write_b128 v10, v[96:99] offset:2048
    ds_write_b128 v10, v[100:103] offset:2064
    v_lshrrev_b32 v11, 5, v2
    v_lshlrev_b32 v11, 13, v11
    v_and_b32 v12, 31, v2
    v_lshl_add_u32 v11, v12, 2, v11
    s_lshl_b32 s31, s3, 8
    v_add_u32 v11, s31, v11
    v_add_u32 v12, 128, v11
    s_lshl_b32 s31, s3, 18
    s_lshl_b32 s4, s28, 12
    s_add_u32 s31, s31, s4
    s_add_u32 s31, s31, 6291456
    s_waitcnt lgkmcnt(0)
    s_barrier
    ds_read2st64_b32 v[16:17], v11 offset0:0 offset1:8
    ds_read2st64_b32 v[18:19], v11 offset0:16 offset1:24
    ds_read2st64_b32 v[20:21], v12 offset0:0 offset1:8
    ds_read2st64_b32 v[22:23], v12 offset0:16 offset1:24
    ds_read2st64_b32 v[24:25], v11 offset0:64 offset1:72
    ds_read2st64_b32 v[26:27], v11 offset0:80 offset1:88
    ds_read2st64_b32 v[28:29], v12 offset0:64 offset1:72
    ds_read2st64_b32 v[30:31], v12 offset0:80 offset1:88
    s_waitcnt lgkmcnt(6)
    buffer_store_dwordx4 v[16:19], v14, s[20:23], s31 offen offset:0 sc1
    s_waitcnt lgkmcnt(4)
    buffer_store_dwordx4 v[20:23], v14, s[20:23], s31 offen offset:1024 sc1
    s_waitcnt lgkmcnt(2)
    buffer_store_dwordx4 v[24:27], v14, s[20:23], s31 offen offset:2048 sc1
    s_waitcnt lgkmcnt(0)
    buffer_store_dwordx4 v[28:31], v14, s[20:23], s31 offen offset:3072 sc1
    v_mov_b32 v104, 157696
    s_lshl_b32 s30, s28, 7
    s_add_u32 s30, s30, 13631488
    s_waitcnt vmcnt(0)
    s_barrier
    s_cmp_lg_u32 s3, 0
    s_cbranch_scc1 L_attn
    ds_read_b32 v105, v104 offset:76
    s_waitcnt lgkmcnt(0)
    v_readfirstlane_b32 s35, v105
    s_nop 1
    v_lshlrev_b32 v105, 2, v2
    v_mov_b32 v106, s35
    s_waitcnt vmcnt(0)
    s_mov_b32 exec_hi, 0
    buffer_store_dword v106, v105, s[20:23], s30 offen sc1
    s_mov_b64 exec, -1
    s_branch L_attn
L_comp:
    s_and_b32 s32, s3, 1
    s_lshr_b32 s33, s3, 1
    v_and_b32 v14, 31, v2
    v_lshrrev_b32 v15, 5, v2
    v_lshrrev_b32 v16, 1, v14
    v_and_b32 v16, 7, v16
    s_lshl_b32 s8, s32, 13
    v_lshl_add_u32 v17, v14, 7, s8
    v_add_u32 v18, 0, v15
    v_xor_b32 v18, v18, v16
    v_lshl_add_u32 v8, v18, 4, v17
    v_add_u32 v18, 2, v15
    v_xor_b32 v18, v18, v16
    v_lshl_add_u32 v9, v18, 4, v17
    v_add_u32 v18, 4, v15
    v_xor_b32 v18, v18, v16
    v_lshl_add_u32 v10, v18, 4, v17
    v_add_u32 v18, 6, v15
    v_xor_b32 v18, v18, v16
    v_lshl_add_u32 v11, v18, 4, v17
    v_bfe_u32 v16, v2, 2, 2
    v_lshl_add_u32 v17, v15, 3, v16
    v_lshlrev_b32 v17, 8, v17
    v_bfe_u32 v18, v2, 4, 1
    v_lshl_add_u32 v17, v18, 5, v17
    v_and_b32 v18, 3, v2
    v_lshl_add_u32 v17, v18, 3, v17
    v_add_u32 v17, 16384, v17
    s_lshl_b32 s8, s33, 1
    v_xor_b32 v18, s8, v16
    v_lshl_add_u32 v12, v18, 6, v17
    v_xor_b32 v18, 1, v18
    v_lshl_add_u32 v13, v18, 6, v17
    v_mov_b32 v32, 0
    v_mov_b32 v33, 0
    v_mov_b32 v34, 0
    v_mov_b32 v35, 0
    v_mov_b32 v36, 0
    v_mov_b32 v37, 0
    v_mov_b32 v38, 0
    v_mov_b32 v39, 0
    v_mov_b32 v40, 0
    v_mov_b32 v41, 0
    v_mov_b32 v42, 0
    v_mov_b32 v43, 0
    v_mov_b32 v44, 0
    v_mov_b32 v45, 0
    v_mov_b32 v46, 0
    v_mov_b32 v47, 0
    v_mov_b32 v48, 0
    v_mov_b32 v49, 0
    v_mov_b32 v50, 0
    v_mov_b32 v51, 0
    v_mov_b32 v52, 0
    v_mov_b32 v53, 0
    v_mov_b32 v54, 0
    v_mov_b32 v55, 0
    v_mov_b32 v56, 0
    v_mov_b32 v57, 0
    v_mov_b32 v58, 0
    v_mov_b32 v59, 0
    v_mov_b32 v60, 0
    v_mov_b32 v61, 0
    v_mov_b32 v62, 0
    v_mov_b32 v63, 0
    v_mov_b32 v64, 0
    v_mov_b32 v65, 0
    v_mov_b32 v66, 0
    v_mov_b32 v67, 0
    v_mov_b32 v68, 0
    v_mov_b32 v69, 0
    v_mov_b32 v70, 0
    v_mov_b32 v71, 0
    v_mov_b32 v72, 0
    v_mov_b32 v73, 0
    v_mov_b32 v74, 0
    v_mov_b32 v75, 0
    v_mov_b32 v76, 0
    v_mov_b32 v77, 0
    v_mov_b32 v78, 0
    v_mov_b32 v79, 0
    v_mov_b32 v80, 0
    v_mov_b32 v81, 0
    v_mov_b32 v82, 0
    v_mov_b32 v83, 0
    v_mov_b32 v84, 0
    v_mov_b32 v85, 0
    v_mov_b32 v86, 0
    v_mov_b32 v87, 0
    v_mov_b32 v88, 0
    v_mov_b32 v89, 0
    v_mov_b32 v90, 0
    v_mov_b32 v91, 0
    v_mov_b32 v92, 0
    v_mov_b32 v93, 0
    v_mov_b32 v94, 0
    v_mov_b32 v95, 0
    s_lshr_b32 s8, s27, 2
    s_cmp_eq_u32 s8, 0
    s_cbranch_scc0 L_c_kv
    s_mov_b32 s28, 0
    s_mov_b32 s29, 65536
    s_mov_b32 s6, 1024
    s_mov_b32 s7, 65536
    s_mov_b32 s10, 0x3eb8aa3b
    v_lshlrev_b32 v20, 4, v2
    s_branch L_c_par
L_c_kv:
    s_mov_b32 s29, 131072
    s_mov_b32 s6, 2048
    s_mov_b32 s10, 1.0
    s_cmp_eq_u32 s8, 1
    s_cbranch_scc0 L_c_v
    s_mov_b32 s28, 2097152
    s_mov_b32 s7, 131072
    v_and_b32 v20, 0x33, v2
    v_bfe_u32 v21, v2, 2, 1
    v_lshl_or_b32 v20, v21, 3, v20
    v_bfe_u32 v21, v2, 3, 1
    v_lshl_or_b32 v20, v21, 2, v20
    v_lshlrev_b32 v20, 4, v20
    s_branch L_c_par
L_c_v:
    s_mov_b32 s28, 2098176
    s_mov_b32 s7, 256
    v_bfe_u32 v20, v2, 4, 1
    v_lshlrev_b32 v20, 17, v20
    v_lshl_add_u32 v20, v15, 9, v20
    v_and_b32 v21, 15, v2
    v_lshl_add_u32 v20, v21, 4, v20
L_c_par:
    s_and_b32 s4, s27, 3
    s_lshl_b32 s4, s4, 1
    s_add_u32 s4, s4, s33
    s_lshl_b32 s5, s4, 2
    s_mul_i32 s5, s5, s29
    s_add_u32 s28, s28, s5
    s_lshl_b32 s5, s26, 1
    s_add_u32 s5, s5, s32
    s_mul_i32 s30, s4, 3
    s_add_u32 s30, s30, s8
    s_lshl_b32 s30, s30, 5
    s_add_u32 s30, s30, s5
    s_lshl_b32 s30, s30, 7
    s_add_u32 s30, s30, 12582912
    s_lshl_b32 s5, s5, 1
    s_mul_i32 s5, s5, s6
    s_add_u32 s28, s28, s5
    s_lshl_b32 s29, s29, 1
    s_mov_b32 s11, s10
    v_mov_b32 v24, 157696
    v_mov_b32 v27, 1
    s_waitcnt lgkmcnt(0)
    s_mov_b32 s20, s58
    s_and_b32 s21, s59, 0xffff
    s_mov_b32 s22, 0x10000000
    s_mov_b32 s23, 0x00020000
    v_lshlrev_b32 v25, 2, v2
    v_mov_b32 v26, 0
    s_mov_b32 exec_hi, 0
    buffer_store_dword v26, v25, s[20:23], s30 offen sc1
    s_mov_b64 exec, -1
    s_cmp_eq_u32 s8, 2
    s_barrier
    s_cbranch_scc1 L_c_vl
    ds_read_b128 v[96:99], v8 offset:0
    ds_read_b64_tr_b16 v[112:113], v12 offset:0
    ds_read_b64_tr_b16 v[114:115], v12 offset:1024
    ds_read_b128 v[100:103], v8 offset:4096
    ds_read_b64_tr_b16 v[116:117], v13 offset:0
    ds_read_b64_tr_b16 v[118:119], v13 offset:1024
    s_mov_b32 s9, 0
.p2align 3
L_qloop:
    s_waitcnt lgkmcnt(3)
    s_nop 0
    v_mfma_f32_32x32x16_bf16 v[32:47], v[112:115], v[96:99], v[32:47]
    ds_read_b128 v[104:107], v9 offset:0
    ds_read_b64_tr_b16 v[120:121], v12 offset:4096
    s_waitcnt lgkmcnt(4)
    s_nop 0
    v_mfma_f32_32x32x16_bf16 v[48:63], v[112:115], v[100:103], v[48:63]
    ds_read_b64_tr_b16 v[122:123], v12 offset:5120
    ds_read_b128 v[108:111], v9 offset:4096
    s_waitcnt lgkmcnt(4)
    s_nop 0
    v_mfma_f32_32x32x16_bf16 v[64:79], v[116:119], v[96:99], v[64:79]
    ds_read_b64_tr_b16 v[124:125], v13 offset:4096
    ds_read_b64_tr_b16 v[126:127], v13 offset:5120
    v_mfma_f32_32x32x16_bf16 v[80:95], v[116:119], v[100:103], v[80:95]
    s_waitcnt lgkmcnt(3)
    s_nop 0
    v_mfma_f32_32x32x16_bf16 v[32:47], v[120:123], v[104:107], v[32:47]
    ds_read_b128 v[96:99], v10 offset:0
    ds_read_b64_tr_b16 v[112:113], v12 offset:8192
    s_waitcnt lgkmcnt(4)
    s_nop 0
    v_mfma_f32_32x32x16_bf16 v[48:63], v[120:123], v[108:111], v[48:63]
    ds_read_b64_tr_b16 v[114:115], v12 offset:9216
    ds_read_b128 v[100:103], v10 offset:4096
    s_waitcnt lgkmcnt(4)
    s_nop 0
    v_mfma_f32_32x32x16_bf16 v[64:79], v[124:127], v[104:107], v[64:79]
    ds_read_b64_tr_b16 v[116:117], v13 offset:8192
    ds_read_b64_tr_b16 v[118:119], v13 offset:9216
    v_mfma_f32_32x32x16_bf16 v[80:95], v[124:127], v[108:111], v[80:95]
    s_waitcnt lgkmcnt(3)
    s_nop 0
    v_mfma_f32_32x32x16_bf16 v[32:47], v[112:115], v[96:99], v[32:47]
    ds_read_b128 v[104:107], v11 offset:0
    ds_read_b64_tr_b16 v[120:121], v12 offset:12288
    s_waitcnt lgkmcnt(4)
    s_nop 0
    v_mfma_f32_32x32x16_bf16 v[48:63], v[112:115], v[100:103], v[48:63]
    ds_read_b64_tr_b16 v[122:123], v12 offset:13312
    ds_read_b128 v[108:111], v11 offset:4096
    s_waitcnt lgkmcnt(4)
    s_nop 0
    v_mfma_f32_32x32x16_bf16 v[64:79], v[116:119], v[96:99], v[64:79]
    ds_read_b64_tr_b16 v[124:125], v13 offset:12288
    ds_read_b64_tr_b16 v[126:127], v13 offset:13312
    v_mfma_f32_32x32x16_bf16 v[80:95], v[116:119], v[100:103], v[80:95]
    s_waitcnt lgkmcnt(3)
    s_nop 0
    v_mfma_f32_32x32x16_bf16 v[32:47], v[120:123], v[104:107], v[32:47]
    s_waitcnt lgkmcnt(2)
    s_nop 0
    v_mfma_f32_32x32x16_bf16 v[48:63], v[120:123], v[108:111], v[48:63]
    s_waitcnt lgkmcnt(0)
    s_barrier
    ds_read_b128 v[96:99], v8 offset:32768
    ds_read_b64_tr_b16 v[112:113], v12 offset:32768
    ds_read_b64_tr_b16 v[114:115], v12 offset:33792
    v_mfma_f32_32x32x16_bf16 v[64:79], v[124:127], v[104:107], v[64:79]
    ds_read_b128 v[100:103], v8 offset:36864
    ds_read_b64_tr_b16 v[116:117], v13 offset:32768
    ds_read_b64_tr_b16 v[118:119], v13 offset:33792
    v_mfma_f32_32x32x16_bf16 v[80:95], v[124:127], v[108:111], v[80:95]
    s_waitcnt lgkmcnt(3)
    s_nop 0
    v_mfma_f32_32x32x16_bf16 v[32:47], v[112:115], v[96:99], v[32:47]
    ds_read_b128 v[104:107], v9 offset:32768
    ds_read_b64_tr_b16 v[120:121], v12 offset:36864
    s_waitcnt lgkmcnt(4)
    s_nop 0
    v_mfma_f32_32x32x16_bf16 v[48:63], v[112:115], v[100:103], v[48:63]
    ds_read_b64_tr_b16 v[122:123], v12 offset:37888
    ds_read_b128 v[108:111], v9 offset:36864
    s_waitcnt lgkmcnt(4)
    s_nop 0
    v_mfma_f32_32x32x16_bf16 v[64:79], v[116:119], v[96:99], v[64:79]
    ds_read_b64_tr_b16 v[124:125], v13 offset:36864
    ds_read_b64_tr_b16 v[126:127], v13 offset:37888
    v_mfma_f32_32x32x16_bf16 v[80:95], v[116:119], v[100:103], v[80:95]
    s_waitcnt lgkmcnt(3)
    s_nop 0
    v_mfma_f32_32x32x16_bf16 v[32:47], v[120:123], v[104:107], v[32:47]
    ds_read_b128 v[96:99], v10 offset:32768
    ds_read_b64_tr_b16 v[112:113], v12 offset:40960
    s_waitcnt lgkmcnt(4)
    s_nop 0
    v_mfma_f32_32x32x16_bf16 v[48:63], v[120:123], v[108:111], v[48:63]
    ds_read_b64_tr_b16 v[114:115], v12 offset:41984
    ds_read_b128 v[100:103], v10 offset:36864
    s_waitcnt lgkmcnt(4)
    s_nop 0
    v_mfma_f32_32x32x16_bf16 v[64:79], v[124:127], v[104:107], v[64:79]
    ds_read_b64_tr_b16 v[116:117], v13 offset:40960
    ds_read_b64_tr_b16 v[118:119], v13 offset:41984
    v_mfma_f32_32x32x16_bf16 v[80:95], v[124:127], v[108:111], v[80:95]
    s_waitcnt lgkmcnt(3)
    s_nop 0
    v_mfma_f32_32x32x16_bf16 v[32:47], v[112:115], v[96:99], v[32:47]
    ds_read_b128 v[104:107], v11 offset:32768
    ds_read_b64_tr_b16 v[120:121], v12 offset:45056
    s_waitcnt lgkmcnt(4)
    s_nop 0
    v_mfma_f32_32x32x16_bf16 v[48:63], v[112:115], v[100:103], v[48:63]
    ds_read_b64_tr_b16 v[122:123], v12 offset:46080
    ds_read_b128 v[108:111], v11 offset:36864
    s_waitcnt lgkmcnt(4)
    s_nop 0
    v_mfma_f32_32x32x16_bf16 v[64:79], v[116:119], v[96:99], v[64:79]
    ds_read_b64_tr_b16 v[124:125], v13 offset:45056
    ds_read_b64_tr_b16 v[126:127], v13 offset:46080
    v_mfma_f32_32x32x16_bf16 v[80:95], v[116:119], v[100:103], v[80:95]
    s_waitcnt lgkmcnt(3)
    s_nop 0
    v_mfma_f32_32x32x16_bf16 v[32:47], v[120:123], v[104:107], v[32:47]
    v_xor_b32 v8, 0x10000, v8
    v_xor_b32 v9, 0x10000, v9
    v_xor_b32 v10, 0x10000, v10
    v_xor_b32 v11, 0x10000, v11
    v_xor_b32 v12, 0x10000, v12
    v_xor_b32 v13, 0x10000, v13
    s_add_u32 s9, s9, 1
    s_cmp_ge_u32 s9, 4
    s_waitcnt lgkmcnt(2)
.p2align 3
    v_mfma_f32_32x32x16_bf16 v[48:63], v[120:123], v[108:111], v[48:63]
    s_waitcnt lgkmcnt(0)
    s_barrier
    s_cbranch_scc1 L_qlast
.p2align 3
    ds_read_b128 v[96:99], v8 offset:0
    ds_read_b64_tr_b16 v[112:113], v12 offset:0
    ds_read_b64_tr_b16 v[114:115], v12 offset:1024
    v_mfma_f32_32x32x16_bf16 v[64:79], v[124:127], v[104:107], v[64:79]
    ds_read_b128 v[100:103], v8 offset:4096
    ds_read_b64_tr_b16 v[116:117], v13 offset:0
    ds_read_b64_tr_b16 v[118:119], v13 offset:1024
    v_mfma_f32_32x32x16_bf16 v[80:95], v[124:127], v[108:111], v[80:95]
    s_branch L_qloop
L_qlast:
    v_mfma_f32_32x32x16_bf16 v[64:79], v[124:127], v[104:107], v[64:79]
    v_mfma_f32_32x32x16_bf16 v[80:95], v[124:127], v[108:111], v[80:95]
    s_branch L_c_epi
L_c_vl:
    ds_read_b128 v[96:99], v8 offset:0
    ds_read_b64_tr_b16 v[112:113], v12 offset:0
    ds_read_b64_tr_b16 v[114:115], v12 offset:1024
    ds_read_b128 v[100:103], v8 offset:4096
    ds_read_b64_tr_b16 v[116:117], v13 offset:0
    ds_read_b64_tr_b16 v[118:119], v13 offset:1024
    s_mov_b32 s9, 0
.p2align 3
L_vloop:
    s_waitcnt lgkmcnt(3)
    s_nop 0
    v_mfma_f32_32x32x16_bf16 v[32:47], v[96:99], v[112:115], v[32:47]
    ds_read_b128 v[104:107], v9 offset:0
    ds_read_b64_tr_b16 v[120:121], v12 offset:4096
    s_waitcnt lgkmcnt(4)
    s_nop 0
    v_mfma_f32_32x32x16_bf16 v[48:63], v[100:103], v[112:115], v[48:63]
    ds_read_b64_tr_b16 v[122:123], v12 offset:5120
    ds_read_b128 v[108:111], v9 offset:4096
    s_waitcnt lgkmcnt(4)
    s_nop 0
    v_mfma_f32_32x32x16_bf16 v[64:79], v[96:99], v[116:119], v[64:79]
    ds_read_b64_tr_b16 v[124:125], v13 offset:4096
    ds_read_b64_tr_b16 v[126:127], v13 offset:5120
    v_mfma_f32_32x32x16_bf16 v[80:95], v[100:103], v[116:119], v[80:95]
    s_waitcnt lgkmcnt(3)
    s_nop 0
    v_mfma_f32_32x32x16_bf16 v[32:47], v[104:107], v[120:123], v[32:47]
    ds_read_b128 v[96:99], v10 offset:0
    ds_read_b64_tr_b16 v[112:113], v12 offset:8192
    s_waitcnt lgkmcnt(4)
    s_nop 0
    v_mfma_f32_32x32x16_bf16 v[48:63], v[108:111], v[120:123], v[48:63]
    ds_read_b64_tr_b16 v[114:115], v12 offset:9216
    ds_read_b128 v[100:103], v10 offset:4096
    s_waitcnt lgkmcnt(4)
    s_nop 0
    v_mfma_f32_32x32x16_bf16 v[64:79], v[104:107], v[124:127], v[64:79]
    ds_read_b64_tr_b16 v[116:117], v13 offset:8192
    ds_read_b64_tr_b16 v[118:119], v13 offset:9216
    v_mfma_f32_32x32x16_bf16 v[80:95], v[108:111], v[124:127], v[80:95]
    s_waitcnt lgkmcnt(3)
    s_nop 0
    v_mfma_f32_32x32x16_bf16 v[32:47], v[96:99], v[112:115], v[32:47]
    ds_read_b128 v[104:107], v11 offset:0
    ds_read_b64_tr_b16 v[120:121], v12 offset:12288
    s_waitcnt lgkmcnt(4)
    s_nop 0
    v_mfma_f32_32x32x16_bf16 v[48:63], v[100:103], v[112:115], v[48:63]
    ds_read_b64_tr_b16 v[122:123], v12 offset:13312
    ds_read_b128 v[108:111], v11 offset:4096
    s_waitcnt lgkmcnt(4)
    s_nop 0
    v_mfma_f32_32x32x16_bf16 v[64:79], v[96:99], v[116:119], v[64:79]
    ds_read_b64_tr_b16 v[124:125], v13 offset:12288
    ds_read_b64_tr_b16 v[126:127], v13 offset:13312
    v_mfma_f32_32x32x16_bf16 v[80:95], v[100:103], v[116:119], v[80:95]
    s_waitcnt lgkmcnt(3)
    s_nop 0
    v_mfma_f32_32x32x16_bf16 v[32:47], v[104:107], v[120:123], v[32:47]
    s_waitcnt lgkmcnt(2)
    s_nop 0
    v_mfma_f32_32x32x16_bf16 v[48:63], v[108:111], v[120:123], v[48:63]
    s_waitcnt lgkmcnt(0)
    s_barrier
    ds_read_b128 v[96:99], v8 offset:32768
    ds_read_b64_tr_b16 v[112:113], v12 offset:32768
    ds_read_b64_tr_b16 v[114:115], v12 offset:33792
    v_mfma_f32_32x32x16_bf16 v[64:79], v[104:107], v[124:127], v[64:79]
    ds_read_b128 v[100:103], v8 offset:36864
    ds_read_b64_tr_b16 v[116:117], v13 offset:32768
    ds_read_b64_tr_b16 v[118:119], v13 offset:33792
    v_mfma_f32_32x32x16_bf16 v[80:95], v[108:111], v[124:127], v[80:95]
    s_waitcnt lgkmcnt(3)
    s_nop 0
    v_mfma_f32_32x32x16_bf16 v[32:47], v[96:99], v[112:115], v[32:47]
    ds_read_b128 v[104:107], v9 offset:32768
    ds_read_b64_tr_b16 v[120:121], v12 offset:36864
    s_waitcnt lgkmcnt(4)
    s_nop 0
    v_mfma_f32_32x32x16_bf16 v[48:63], v[100:103], v[112:115], v[48:63]
    ds_read_b64_tr_b16 v[122:123], v12 offset:37888
    ds_read_b128 v[108:111], v9 offset:36864
    s_waitcnt lgkmcnt(4)
    s_nop 0
    v_mfma_f32_32x32x16_bf16 v[64:79], v[96:99], v[116:119], v[64:79]
    ds_read_b64_tr_b16 v[124:125], v13 offset:36864
    ds_read_b64_tr_b16 v[126:127], v13 offset:37888
    v_mfma_f32_32x32x16_bf16 v[80:95], v[100:103], v[116:119], v[80:95]
    s_waitcnt lgkmcnt(3)
    s_nop 0
    v_mfma_f32_32x32x16_bf16 v[32:47], v[104:107], v[120:123], v[32:47]
    ds_read_b128 v[96:99], v10 offset:32768
    ds_read_b64_tr_b16 v[112:113], v12 offset:40960
    s_waitcnt lgkmcnt(4)
    s_nop 0
    v_mfma_f32_32x32x16_bf16 v[48:63], v[108:111], v[120:123], v[48:63]
    ds_read_b64_tr_b16 v[114:115], v12 offset:41984
    ds_read_b128 v[100:103], v10 offset:36864
    s_waitcnt lgkmcnt(4)
    s_nop 0
    v_mfma_f32_32x32x16_bf16 v[64:79], v[104:107], v[124:127], v[64:79]
    ds_read_b64_tr_b16 v[116:117], v13 offset:40960
    ds_read_b64_tr_b16 v[118:119], v13 offset:41984
    v_mfma_f32_32x32x16_bf16 v[80:95], v[108:111], v[124:127], v[80:95]
    s_waitcnt lgkmcnt(3)
    s_nop 0
    v_mfma_f32_32x32x16_bf16 v[32:47], v[96:99], v[112:115], v[32:47]
    ds_read_b128 v[104:107], v11 offset:32768
    ds_read_b64_tr_b16 v[120:121], v12 offset:45056
    s_waitcnt lgkmcnt(4)
    s_nop 0
    v_mfma_f32_32x32x16_bf16 v[48:63], v[100:103], v[112:115], v[48:63]
    ds_read_b64_tr_b16 v[122:123], v12 offset:46080
    ds_read_b128 v[108:111], v11 offset:36864
    s_waitcnt lgkmcnt(4)
    s_nop 0
    v_mfma_f32_32x32x16_bf16 v[64:79], v[96:99], v[116:119], v[64:79]
    ds_read_b64_tr_b16 v[124:125], v13 offset:45056
    ds_read_b64_tr_b16 v[126:127], v13 offset:46080
    v_mfma_f32_32x32x16_bf16 v[80:95], v[100:103], v[116:119], v[80:95]
    s_waitcnt lgkmcnt(3)
    s_nop 0
    v_mfma_f32_32x32x16_bf16 v[32:47], v[104:107], v[120:123], v[32:47]
    v_xor_b32 v8, 0x10000, v8
    v_xor_b32 v9, 0x10000, v9
    v_xor_b32 v10, 0x10000, v10
    v_xor_b32 v11, 0x10000, v11
    v_xor_b32 v12, 0x10000, v12
    v_xor_b32 v13, 0x10000, v13
    s_add_u32 s9, s9, 1
    s_cmp_ge_u32 s9, 4
    s_waitcnt lgkmcnt(2)
.p2align 3
    v_mfma_f32_32x32x16_bf16 v[48:63], v[108:111], v[120:123], v[48:63]
    s_waitcnt lgkmcnt(0)
    s_barrier
    s_cbranch_scc1 L_vlast
.p2align 3
    ds_read_b128 v[96:99], v8 offset:0
    ds_read_b64_tr_b16 v[112:113], v12 offset:0
    ds_read_b64_tr_b16 v[114:115], v12 offset:1024
    v_mfma_f32_32x32x16_bf16 v[64:79], v[104:107], v[124:127], v[64:79]
    ds_read_b128 v[100:103], v8 offset:4096
    ds_read_b64_tr_b16 v[116:117], v13 offset:0
    ds_read_b64_tr_b16 v[118:119], v13 offset:1024
    v_mfma_f32_32x32x16_bf16 v[80:95], v[108:111], v[124:127], v[80:95]
    s_branch L_vloop
L_vlast:
    v_mfma_f32_32x32x16_bf16 v[64:79], v[104:107], v[124:127], v[64:79]
    v_mfma_f32_32x32x16_bf16 v[80:95], v[108:111], v[124:127], v[80:95]
L_c_epi:
    ds_read_b32 v25, v24 offset:76
    s_waitcnt lgkmcnt(0)
    v_readfirstlane_b32 s35, v25
    s_nop 1
    s_nop 8
    v_pk_mul_f32 v[32:33], v[32:33], s[10:11]
    v_pk_mul_f32 v[34:35], v[34:35], s[10:11]
    v_pk_mul_f32 v[36:37], v[36:37], s[10:11]
    v_pk_mul_f32 v[38:39], v[38:39], s[10:11]
    v_pk_mul_f32 v[40:41], v[40:41], s[10:11]
    v_pk_mul_f32 v[42:43], v[42:43], s[10:11]
    v_pk_mul_f32 v[44:45], v[44:45], s[10:11]
    v_pk_mul_f32 v[46:47], v[46:47], s[10:11]
    v_cvt_pk_bf16_f32 v96, v32, v33
    v_cvt_pk_bf16_f32 v97, v34, v35
    v_cvt_pk_bf16_f32 v98, v36, v37
    v_cvt_pk_bf16_f32 v99, v38, v39
    s_mov_b32 s31, s28
    buffer_store_dwordx4 v[96:99], v20, s[20:23], s31 offen sc1
    v_cvt_pk_bf16_f32 v100, v40, v41
    v_cvt_pk_bf16_f32 v101, v42, v43
    v_cvt_pk_bf16_f32 v102, v44, v45
    v_cvt_pk_bf16_f32 v103, v46, v47
    s_mov_b32 s31, s28
    s_add_u32 s31, s31, s7
    buffer_store_dwordx4 v[100:103], v20, s[20:23], s31 offen sc1
    v_pk_mul_f32 v[48:49], v[48:49], s[10:11]
    v_pk_mul_f32 v[50:51], v[50:51], s[10:11]
    v_pk_mul_f32 v[52:53], v[52:53], s[10:11]
    v_pk_mul_f32 v[54:55], v[54:55], s[10:11]
    v_pk_mul_f32 v[56:57], v[56:57], s[10:11]
    v_pk_mul_f32 v[58:59], v[58:59], s[10:11]
    v_pk_mul_f32 v[60:61], v[60:61], s[10:11]
    v_pk_mul_f32 v[62:63], v[62:63], s[10:11]
    v_cvt_pk_bf16_f32 v104, v48, v49
    v_cvt_pk_bf16_f32 v105, v50, v51
    v_cvt_pk_bf16_f32 v106, v52, v53
    v_cvt_pk_bf16_f32 v107, v54, v55
    s_mov_b32 s31, s28
    s_add_u32 s31, s31, s6
    buffer_store_dwordx4 v[104:107], v20, s[20:23], s31 offen sc1
    v_cvt_pk_bf16_f32 v108, v56, v57
    v_cvt_pk_bf16_f32 v109, v58, v59
    v_cvt_pk_bf16_f32 v110, v60, v61
    v_cvt_pk_bf16_f32 v111, v62, v63
    s_mov_b32 s31, s28
    s_add_u32 s31, s31, s6
    s_add_u32 s31, s31, s7
    buffer_store_dwordx4 v[108:111], v20, s[20:23], s31 offen sc1
    v_pk_mul_f32 v[64:65], v[64:65], s[10:11]
    v_pk_mul_f32 v[66:67], v[66:67], s[10:11]
    v_pk_mul_f32 v[68:69], v[68:69], s[10:11]
    v_pk_mul_f32 v[70:71], v[70:71], s[10:11]
    v_pk_mul_f32 v[72:73], v[72:73], s[10:11]
    v_pk_mul_f32 v[74:75], v[74:75], s[10:11]
    v_pk_mul_f32 v[76:77], v[76:77], s[10:11]
    v_pk_mul_f32 v[78:79], v[78:79], s[10:11]
    v_cvt_pk_bf16_f32 v112, v64, v65
    v_cvt_pk_bf16_f32 v113, v66, v67
    v_cvt_pk_bf16_f32 v114, v68, v69
    v_cvt_pk_bf16_f32 v115, v70, v71
    s_mov_b32 s31, s28
    s_add_u32 s31, s31, s29
    buffer_store_dwordx4 v[112:115], v20, s[20:23], s31 offen sc1
    v_cvt_pk_bf16_f32 v116, v72, v73
    v_cvt_pk_bf16_f32 v117, v74, v75
    v_cvt_pk_bf16_f32 v118, v76, v77
    v_cvt_pk_bf16_f32 v119, v78, v79
    s_mov_b32 s31, s28
    s_add_u32 s31, s31, s29
    s_add_u32 s31, s31, s7
    buffer_store_dwordx4 v[116:119], v20, s[20:23], s31 offen sc1
    v_pk_mul_f32 v[80:81], v[80:81], s[10:11]
    v_pk_mul_f32 v[82:83], v[82:83], s[10:11]
    v_pk_mul_f32 v[84:85], v[84:85], s[10:11]
    v_pk_mul_f32 v[86:87], v[86:87], s[10:11]
    v_pk_mul_f32 v[88:89], v[88:89], s[10:11]
    v_pk_mul_f32 v[90:91], v[90:91], s[10:11]
    v_pk_mul_f32 v[92:93], v[92:93], s[10:11]
    v_pk_mul_f32 v[94:95], v[94:95], s[10:11]
    v_cvt_pk_bf16_f32 v120, v80, v81
    v_cvt_pk_bf16_f32 v121, v82, v83
    v_cvt_pk_bf16_f32 v122, v84, v85
    v_cvt_pk_bf16_f32 v123, v86, v87
    s_mov_b32 s31, s28
    s_add_u32 s31, s31, s29
    s_add_u32 s31, s31, s6
    buffer_store_dwordx4 v[120:123], v20, s[20:23], s31 offen sc1
    v_cvt_pk_bf16_f32 v124, v88, v89
    v_cvt_pk_bf16_f32 v125, v90, v91
    v_cvt_pk_bf16_f32 v126, v92, v93
    v_cvt_pk_bf16_f32 v127, v94, v95
    s_mov_b32 s31, s28
    s_add_u32 s31, s31, s29
    s_add_u32 s31, s31, s6
    s_add_u32 s31, s31, s7
    buffer_store_dwordx4 v[124:127], v20, s[20:23], s31 offen sc1
    s_mov_b64 exec, 1
    ds_add_u32 v24, v27 offset:156
    s_mov_b64 exec, -1
    v_lshlrev_b32 v25, 2, v2
    v_mov_b32 v26, s35
    s_waitcnt vmcnt(0)
    s_mov_b32 exec_hi, 0
    buffer_store_dword v26, v25, s[20:23], s30 offen sc1
    s_mov_b64 exec, -1
    s_mov_b64 exec, 1
    ds_add_u32 v24, v27 offset:88
    s_mov_b64 exec, -1
L_attn:
    s_lshl_b32 s26, s24, 2
    s_lshr_b32 s27, s25, 3
    s_add_u32 s26, s26, s27
    s_and_b32 s27, s25, 7
    s_lshl_b32 s27, s27, 3
    s_add_u32 s27, s27, s3
    v_lshlrev_b32 v100, 4, v2
    s_lshl_b32 s28, s26, 17
    s_and_b32 s29, s3, 3
    s_lshl_b32 s29, s29, 12
    s_add_u32 s28, s28, s29
    s_add_u32 s28, s28, 2097152
    s_lshr_b32 s6, s3, 2
    s_add_u32 s6, s6, s25
    s_mul_i32 s29, s3, 4160
    s_lshl_b32 s30, s26, 16
    s_lshl_b32 s31, s27, 10
    s_add_u32 s30, s30, s31
    v_mov_b32 v92, 0xdddddddd
    v_mov_b32 v98, 157696
    v_mov_b32 v99, 157700
    v_mov_b32 v101, 1
    s_mov_b32 s8, 0
    s_mov_b32 s9, 0
    ds_read_b32 v96, v98 offset:76
    s_waitcnt lgkmcnt(0)
    v_readfirstlane_b32 s35, v96
    s_nop 1
    s_lshr_b32 s31, s26, 2
    s_mul_i32 s31, s31, 12288
    s_add_u32 s31, s31, 12582912
    s_cmp_eq_u32 s3, 5
    s_cbranch_scc1 L_a_pq
    s_cmp_lg_u32 s3, 4
    s_cbranch_scc1 L_a_wait
    v_mul_u32_u24 v96, 2080, v2
    v_mov_b32 v40, 0x3f803f80
    v_mov_b32 v41, 0x3f803f80
    v_mov_b32 v42, 0x3f803f80
    v_mov_b32 v43, 0x3f803f80
    v_mov_b32 v44, 0
    v_mov_b32 v45, 0
    v_mov_b32 v46, 0
    v_mov_b32 v47, 0
    ds_write_b128 v96, v[40:43] offset:2048
    ds_write_b128 v96, v[44:47] offset:2064
    s_add_u32 s31, s31, 4096
    s_lshl_b32 s4, s25, 2
    v_and_b32 v97, 7, v2
    v_add_u32 v97, s4, v97
    v_and_b32 v97, 31, v97
    v_and_b32 v93, 8, v2
    v_lshl_add_u32 v97, v93, 2, v97
    v_lshlrev_b32 v97, 7, v97
    s_branch L_a_pp
L_a_pq:
    s_and_b32 s4, s25, 7
    s_lshl_b32 s4, s4, 9
    s_add_u32 s31, s31, s4
    v_and_b32 v97, 3, v2
    v_lshlrev_b32 v97, 7, v97
L_a_pp:
L_gated__lw_1:
    ds_read_b32 v96, v98 offset:88
    s_waitcnt lgkmcnt(0)
    v_readfirstlane_b32 s4, v96
    s_cmp_ge_u32 s4, 4
    s_cbranch_scc1 L_gated__lwd_2
    s_sleep 2
    s_branch L_gated__lw_1
L_gated__lwd_2:
    s_mov_b32 s5, 0
L_gated__fp_3:
    buffer_load_dword v96, v97, s[20:23], s31 offen sc1
    s_add_u32 s5, s5, 1
    s_waitcnt vmcnt(0)
    v_cmp_ne_u32 vcc, s35, v96
    s_and_b64 exec, exec, vcc
    s_cbranch_scc0 L_gated__fpd_4
    s_sleep 2
    s_cmp_lt_u32 s5, 262144
    s_cbranch_scc1 L_gated__fp_3
L_gated__fpd_4:
    s_mov_b64 exec, -1
    s_mov_b64 exec, 1
    ds_add_u32 v98, v101 offset:72
    s_mov_b64 exec, -1
L_a_wait:
L_gated__lw_5:
    ds_read_b32 v96, v98 offset:88
    s_waitcnt lgkmcnt(0)
    v_readfirstlane_b32 s4, v96
    s_cmp_ge_u32 s4, 4
    s_cbranch_scc1 L_gated__lwd_6
    s_sleep 4
    s_branch L_gated__lw_5
L_gated__lwd_6:
L_gated__lw_7:
    ds_read_b32 v96, v98 offset:72
    s_waitcnt lgkmcnt(0)
    v_readfirstlane_b32 s4, v96
    s_cmp_ge_u32 s4, 2
    s_cbranch_scc1 L_gated__lwd_8
    s_sleep 1
    s_branch L_gated__lw_7
L_gated__lwd_8:
L_a_go:
    buffer_load_dwordx4 v[4:7], v100, s[20:23], s30 offen sc1
    s_add_u32 s7, s6, 0
    s_and_b32 s7, s7, 7
    s_lshl_b32 s7, s7, 14
    s_add_u32 s7, s7, s28
    s_add_u32 m0, s29, 0
    s_add_u32 s32, s7, 0
    buffer_load_dwordx4 v100, s[20:23], s32 offen sc1 lds
    buffer_load_dwordx4 v100, s[20:23], s32 offen offset:1024 sc1 lds
    s_add_u32 m0, s29, 2080
    s_add_u32 s32, s7, 2048
    buffer_load_dwordx4 v100, s[20:23], s32 offen sc1 lds
    buffer_load_dwordx4 v100, s[20:23], s32 offen offset:1024 sc1 lds
    s_cmp_ge_u32 s3, 4
    s_cbranch_scc1 L_a_young
    s_waitcnt vmcnt(0)
    s_mov_b64 exec, 1
    ds_add_u32 v98, v101 offset:0
    s_mov_b64 exec, -1
    s_branch L_a_c0
L_a_young:
    s_cmp_lg_u32 s3, 4
    s_cbranch_scc1 L_a_y1
    v_lshlrev_b32 v97, 7, v2
    buffer_load_dword v96, v97, s[20:23], s31 offen sc1
    s_waitcnt vmcnt(1)
    s_mov_b64 exec, 1
    ds_add_u32 v98, v101 offset:4
    ds_add_u32 v98, v101 offset:64
    s_mov_b64 exec, -1
    s_waitcnt vmcnt(0)
    v_cmp_ne_u32 vcc, s35, v96
    s_and_b64 exec, exec, vcc
    s_cbranch_scc0 L_a_y0
    s_mov_b32 s5, 0
L_gated__fp_9:
    buffer_load_dword v96, v97, s[20:23], s31 offen sc1
    s_add_u32 s5, s5, 1
    s_waitcnt vmcnt(0)
    v_cmp_ne_u32 vcc, s35, v96
    s_and_b64 exec, exec, vcc
    s_cbranch_scc0 L_gated__fpd_10
    s_sleep 2
    s_cmp_lt_u32 s5, 262144
    s_cbranch_scc1 L_gated__fp_9
L_gated__fpd_10:
    s_mov_b64 exec, -1
L_a_y0:
    s_mov_b64 exec, -1
    s_mov_b64 exec, 1
    ds_add_u32 v98, v101 offset:72
    s_mov_b64 exec, -1
    s_branch L_a_y2
L_a_y1:
    s_waitcnt vmcnt(0)
    s_mov_b64 exec, 1
    ds_add_u32 v98, v101 offset:4
    ds_add_u32 v98, v101 offset:64
    s_mov_b64 exec, -1
L_gated__lw_11:
    ds_read_b32 v96, v98 offset:72
    s_waitcnt lgkmcnt(0)
    v_readfirstlane_b32 s4, v96
    s_cmp_ge_u32 s4, 3
    s_cbranch_scc1 L_gated__lwd_12
    s_sleep 1
    s_branch L_gated__lw_11
L_gated__lwd_12:
L_a_y2:
    s_add_u32 s7, s6, 1
    s_and_b32 s7, s7, 7
    s_lshl_b32 s7, s7, 14
    s_add_u32 s7, s7, s28
    s_add_u32 m0, s29, 16640
    s_add_u32 s32, s7, 0
    buffer_load_dwordx4 v100, s[20:23], s32 offen sc1 lds
    buffer_load_dwordx4 v100, s[20:23], s32 offen offset:1024 sc1 lds
    s_add_u32 m0, s29, 18720
    s_add_u32 s32, s7, 2048
    buffer_load_dwordx4 v100, s[20:23], s32 offen sc1 lds
    buffer_load_dwordx4 v100, s[20:23], s32 offen offset:1024 sc1 lds
    s_add_u32 s7, s6, 2
    s_and_b32 s7, s7, 7
    s_lshl_b32 s7, s7, 14
    s_add_u32 s7, s7, s28
    s_add_u32 m0, s29, 33280
    s_add_u32 s32, s7, 0
    buffer_load_dwordx4 v100, s[20:23], s32 offen sc1 lds
    buffer_load_dwordx4 v100, s[20:23], s32 offen offset:1024 sc1 lds
    s_add_u32 m0, s29, 35360
    s_add_u32 s32, s7, 2048
    buffer_load_dwordx4 v100, s[20:23], s32 offen sc1 lds
    buffer_load_dwordx4 v100, s[20:23], s32 offen offset:1024 sc1 lds
    s_add_u32 s7, s6, 3
    s_and_b32 s7, s7, 7
    s_lshl_b32 s7, s7, 14
    s_add_u32 s7, s7, s28
    s_add_u32 m0, s29, 49920
    s_add_u32 s32, s7, 0
    buffer_load_dwordx4 v100, s[20:23], s32 offen sc1 lds
    buffer_load_dwordx4 v100, s[20:23], s32 offen offset:1024 sc1 lds
    s_add_u32 m0, s29, 52000
    s_add_u32 s32, s7, 2048
    buffer_load_dwordx4 v100, s[20:23], s32 offen sc1 lds
    buffer_load_dwordx4 v100, s[20:23], s32 offen offset:1024 sc1 lds
    s_waitcnt vmcnt(8)
    s_mov_b64 exec, 1
    ds_add_u32 v98, v101 offset:8
    ds_add_u32 v98, v101 offset:64
    s_mov_b64 exec, -1
    s_add_u32 s7, s6, 4
    s_and_b32 s7, s7, 7
    s_lshl_b32 s7, s7, 14
    s_add_u32 s7, s7, s28
    s_add_u32 m0, s29, 66560
    s_add_u32 s32, s7, 0
    buffer_load_dwordx4 v100, s[20:23], s32 offen sc1 lds
    buffer_load_dwordx4 v100, s[20:23], s32 offen offset:1024 sc1 lds
    s_add_u32 m0, s29, 68640
    s_add_u32 s32, s7, 2048
    buffer_load_dwordx4 v100, s[20:23], s32 offen sc1 lds
    buffer_load_dwordx4 v100, s[20:23], s32 offen offset:1024 sc1 lds
    s_waitcnt vmcnt(8)
    s_mov_b64 exec, 1
    ds_add_u32 v98, v101 offset:12
    ds_add_u32 v98, v101 offset:64
    s_mov_b64 exec, -1
    s_add_u32 s7, s6, 5
    s_and_b32 s7, s7, 7
    s_lshl_b32 s7, s7, 14
    s_add_u32 s7, s7, s28
    s_add_u32 m0, s29, 83200
    s_add_u32 s32, s7, 0
    buffer_load_dwordx4 v100, s[20:23], s32 offen sc1 lds
    buffer_load_dwordx4 v100, s[20:23], s32 offen offset:1024 sc1 lds
    s_add_u32 m0, s29, 85280
    s_add_u32 s32, s7, 2048
    buffer_load_dwordx4 v100, s[20:23], s32 offen sc1 lds
    buffer_load_dwordx4 v100, s[20:23], s32 offen offset:1024 sc1 lds
    s_waitcnt vmcnt(8)
    s_mov_b64 exec, 1
    ds_add_u32 v98, v101 offset:16
    ds_add_u32 v98, v101 offset:64
    s_mov_b64 exec, -1
    s_add_u32 s7, s6, 6
    s_and_b32 s7, s7, 7
    s_lshl_b32 s7, s7, 14
    s_add_u32 s7, s7, s28
    s_add_u32 m0, s29, 99840
    s_add_u32 s32, s7, 0
    buffer_load_dwordx4 v100, s[20:23], s32 offen sc1 lds
    buffer_load_dwordx4 v100, s[20:23], s32 offen offset:1024 sc1 lds
    s_add_u32 m0, s29, 101920
    s_add_u32 s32, s7, 2048
    buffer_load_dwordx4 v100, s[20:23], s32 offen sc1 lds
    buffer_load_dwordx4 v100, s[20:23], s32 offen offset:1024 sc1 lds
    s_waitcnt vmcnt(8)
    s_mov_b64 exec, 1
    ds_add_u32 v98, v101 offset:20
    ds_add_u32 v98, v101 offset:64
    s_mov_b64 exec, -1
    s_waitcnt vmcnt(4)
    s_mov_b64 exec, 1
    ds_add_u32 v98, v101 offset:24
    ds_add_u32 v98, v101 offset:64
    s_mov_b64 exec, -1
    s_waitcnt vmcnt(0)
    s_mov_b64 exec, 1
    ds_add_u32 v98, v101 offset:28
    ds_add_u32 v98, v101 offset:64
    s_mov_b64 exec, -1
L_a_c0:
L_gated__lw_13:
    ds_read_b32 v96, v98 offset:0
    s_waitcnt lgkmcnt(0)
    v_readfirstlane_b32 s4, v96
    s_cmp_ge_u32 s4, 4
    s_cbranch_scc1 L_gated__lwd_14
    s_sleep 0
    s_branch L_gated__lw_13
L_gated__lwd_14:
    s_lshr_b32 s4, s27, 1
    s_lshl_b32 s4, s4, 6
    s_lshl_b32 s5, s26, 1
    s_add_u32 s4, s4, s5
    s_and_b32 s5, s27, 1
    s_add_u32 s4, s4, s5
    s_lshl_b32 s31, s4, 7
    s_add_u32 s31, s31, 13107200
    s_lshl_b32 s30, s4, 10
    s_add_u32 s30, s30, 10485760
    v_lshlrev_b32 v96, 2, v2
    v_mov_b32 v97, 0
    s_mov_b32 exec_hi, 0
    buffer_store_dword v97, v96, s[20:23], s31 offen sc1
    s_mov_b64 exec, -1
    ds_read_b128 v[72:75], v100
    s_waitcnt lgkmcnt(0)
    v_mfma_f32_32x32x16_bf16 v[40:55], v[72:75], v[4:7], 0
    s_nop 15
    v_max3_f32 v96, v40, v41, v42
    v_max3_f32 v96, v96, v43, v44
    v_max3_f32 v96, v96, v45, v46
    v_max3_f32 v96, v96, v47, v48
    v_max3_f32 v96, v96, v49, v50
    v_max3_f32 v96, v96, v51, v52
    v_max3_f32 v96, v96, v53, v54
    v_max_f32 v96, v96, v55
L_a_setmax:
    v_mov_b32 v97, v96
    v_mov_b32 v93, v100
    v_and_b32 v8, 16, v2
    v_permlane32_swap_b32 v96, v97
    v_cmp_eq_u32 vcc, 0, v8
    v_mov_b32 v8, 1024
    v_mov_b32 v9, 768
    v_max_f32 v96, v96, v97
    v_and_b32 v10, 11, v2
    v_cmp_ne_u32 s[4:5], 0, v10
    v_mov_b32 v10, 1040
    v_mov_b32 v11, 784
    s_nop 0
    v_cndmask_b32 v8, v8, v10, s[4:5]
    v_cndmask_b32 v9, v9, v11, s[4:5]
    v_cndmask_b32 v94, v8, v100, vcc
    v_cndmask_b32 v95, v9, v100, vcc
    s_nop 0
    ds_read_b128 v[72:75], v93
    ds_read_b128 v[80:83], v94 offset:1024
    ds_read_b128 v[88:91], v94 offset:1024
    ds_read_b128 v[76:79], v93 offset:2080
    v_sub_f32 v8, 0, v96
    v_sub_f32 v9, 0, v96
    v_sub_f32 v10, 0, v96
    v_sub_f32 v11, 0, v96
    v_sub_f32 v12, 0, v96
    v_sub_f32 v13, 0, v96
    v_sub_f32 v14, 0, v96
    v_sub_f32 v15, 0, v96
    v_sub_f32 v16, 0, v96
    v_sub_f32 v17, 0, v96
    v_sub_f32 v18, 0, v96
    v_sub_f32 v19, 0, v96
    v_sub_f32 v20, 0, v96
    v_sub_f32 v21, 0, v96
    v_sub_f32 v22, 0, v96
    v_sub_f32 v23, 0, v96
    v_mov_b32 v24, 0
    v_mov_b32 v25, 0
    v_mov_b32 v26, 0
    v_mov_b32 v27, 0
    v_mov_b32 v28, 0
    v_mov_b32 v29, 0
    v_mov_b32 v30, 0
    v_mov_b32 v31, 0
    v_mov_b32 v32, 0
    v_mov_b32 v33, 0
    v_mov_b32 v34, 0
    v_mov_b32 v35, 0
    v_mov_b32 v36, 0
    v_mov_b32 v37, 0
    v_mov_b32 v38, 0
    v_mov_b32 v39, 0
    v_mov_b32 v64, 0
    v_mov_b32 v65, 0
    v_mov_b32 v66, 0
    v_mov_b32 v67, 0
    v_mov_b32 v68, 0
    v_mov_b32 v69, 0
    v_mov_b32 v70, 0
    v_mov_b32 v71, 0
    s_waitcnt lgkmcnt(0)
    v_mfma_f32_32x32x16_bf16 v[40:55], v[72:75], v[4:7], v[8:23]
    ds_read_b128 v[72:75], v93 offset:4160
    s_mov_b32 s33, 0
    s_cmp_lt_u32 s3, 4
    s_cselect_b32 s32, 3, 99
    s_setprio 2
    s_nop 10
.p2align 6
L_a_loop:
    v_exp_f32 v40, v40
    v_exp_f32 v41, v41
    v_smfmac_f32_32x32x32_bf16 v[24:39], v[88:91], v[64:71], v92
    ds_read_b128 v[88:91], v95 offset:1280
    ds_read_b128 v[84:87], v94 offset:3104
    v_exp_f32 v42, v42
    v_exp_f32 v43, v43
    v_exp_f32 v44, v44
    v_exp_f32 v45, v45
    v_mfma_f32_32x32x16_bf16 v[56:71], v[76:79], v[4:7], v[8:23]
    ds_read_b128 v[76:79], v93 offset:6240
    v_exp_f32 v46, v46
    v_exp_f32 v47, v47
    v_exp_f32 v48, v48
    v_exp_f32 v49, v49
    v_exp_f32 v50, v50
    v_exp_f32 v51, v51
    v_smfmac_f32_32x32x32_bf16 v[24:39], v[80:83], v[40:47], v92
    s_waitcnt lgkmcnt(1)
    s_nop 0
    v_exp_f32 v52, v52
    v_exp_f32 v53, v53
    v_exp_f32 v54, v54
    v_exp_f32 v55, v55
    v_exp_f32 v56, v56
    v_exp_f32 v57, v57
    v_smfmac_f32_32x32x32_bf16 v[24:39], v[88:91], v[48:55], v92
    ds_read_b128 v[88:91], v95 offset:3360
    ds_read_b128 v[80:83], v94 offset:5184
    v_exp_f32 v58, v58
    v_exp_f32 v59, v59
    v_exp_f32 v60, v60
    v_exp_f32 v61, v61
    v_mfma_f32_32x32x16_bf16 v[40:55], v[72:75], v[4:7], v[8:23]
    ds_read_b128 v[72:75], v93 offset:8320
    v_exp_f32 v62, v62
    v_exp_f32 v63, v63
    v_exp_f32 v64, v64
    v_exp_f32 v65, v65
    v_exp_f32 v66, v66
    v_exp_f32 v67, v67
    v_smfmac_f32_32x32x32_bf16 v[24:39], v[84:87], v[56:63], v92
    s_waitcnt lgkmcnt(1)
    s_cmp_lg_u32 s33, s32
    v_exp_f32 v68, v68
    v_exp_f32 v69, v69
    v_exp_f32 v70, v70
    v_exp_f32 v71, v71
    s_cbranch_scc1 L_gated__lad_15
    s_setprio 1
L_gated__lad_15:
    v_exp_f32 v40, v40
    v_exp_f32 v41, v41
    v_smfmac_f32_32x32x32_bf16 v[24:39], v[88:91], v[64:71], v92
    ds_read_b128 v[88:91], v95 offset:5440
    ds_read_b128 v[84:87], v94 offset:7264
    v_exp_f32 v42, v42
    v_exp_f32 v43, v43
    v_exp_f32 v44, v44
    v_exp_f32 v45, v45
    v_mfma_f32_32x32x16_bf16 v[56:71], v[76:79], v[4:7], v[8:23]
    ds_read_b128 v[76:79], v93 offset:10400
    v_exp_f32 v46, v46
    v_exp_f32 v47, v47
    v_exp_f32 v48, v48
    v_exp_f32 v49, v49
    v_exp_f32 v50, v50
    v_exp_f32 v51, v51
    v_smfmac_f32_32x32x32_bf16 v[24:39], v[80:83], v[40:47], v92
    s_waitcnt lgkmcnt(1)
    s_nop 0
    v_exp_f32 v52, v52
    v_exp_f32 v53, v53
    v_exp_f32 v54, v54
    v_exp_f32 v55, v55
    v_exp_f32 v56, v56
    v_exp_f32 v57, v57
    v_smfmac_f32_32x32x32_bf16 v[24:39], v[88:91], v[48:55], v92
    ds_read_b128 v[88:91], v95 offset:7520
    ds_read_b128 v[80:83], v94 offset:9344
    v_exp_f32 v58, v58
    v_exp_f32 v59, v59
    v_exp_f32 v60, v60
    v_exp_f32 v61, v61
    v_mfma_f32_32x32x16_bf16 v[40:55], v[72:75], v[4:7], v[8:23]
    ds_read_b128 v[72:75], v93 offset:12480
    v_exp_f32 v62, v62
    v_exp_f32 v63, v63
    v_exp_f32 v64, v64
    v_exp_f32 v65, v65
    v_exp_f32 v66, v66
    v_exp_f32 v67, v67
    v_smfmac_f32_32x32x32_bf16 v[24:39], v[84:87], v[56:63], v92
    s_waitcnt lgkmcnt(1)
    s_nop 0
    v_exp_f32 v68, v68
    v_exp_f32 v69, v69
    v_exp_f32 v70, v70
    v_exp_f32 v71, v71
    v_exp_f32 v40, v40
    v_exp_f32 v41, v41
    v_smfmac_f32_32x32x32_bf16 v[24:39], v[88:91], v[64:71], v92
    ds_read_b128 v[88:91], v95 offset:9600
    ds_read_b128 v[84:87], v94 offset:11424
    v_exp_f32 v42, v42
    v_exp_f32 v43, v43
    v_exp_f32 v44, v44
    v_exp_f32 v45, v45
    v_mfma_f32_32x32x16_bf16 v[56:71], v[76:79], v[4:7], v[8:23]
    ds_read_b128 v[76:79], v93 offset:14560
    v_exp_f32 v46, v46
    v_exp_f32 v47, v47
    v_exp_f32 v48, v48
    v_exp_f32 v49, v49
    v_exp_f32 v50, v50
    v_exp_f32 v51, v51
    v_smfmac_f32_32x32x32_bf16 v[24:39], v[80:83], v[40:47], v92
    s_waitcnt lgkmcnt(1)
    s_cmp_lg_u32 s9, 0
    v_exp_f32 v52, v52
    v_exp_f32 v53, v53
    v_exp_f32 v54, v54
    v_exp_f32 v55, v55
    s_cbranch_scc1 L_gated__rdy_16
L_gated__poll_17:
    ds_read_b32 v96, v99
    ds_read_b32 v97, v98 offset:64
    s_waitcnt lgkmcnt(0)
    v_readfirstlane_b32 s4, v96
    v_readfirstlane_b32 s5, v97
    s_cmp_lt_u32 s4, 4
    s_cbranch_scc1 L_gated__poll_17
    s_cmp_ge_u32 s5, 28
    s_cselect_b32 s9, 1, 0
    v_add_u32 v99, 4, v99
.p2align 3
L_gated__rdy_16:
    v_exp_f32 v56, v56
    v_exp_f32 v57, v57
    v_smfmac_f32_32x32x32_bf16 v[24:39], v[88:91], v[48:55], v92
    ds_read_b128 v[88:91], v95 offset:11680
    ds_read_b128 v[80:83], v94 offset:13504
    v_exp_f32 v58, v58
    v_exp_f32 v59, v59
    v_exp_f32 v60, v60
    v_exp_f32 v61, v61
    v_mfma_f32_32x32x16_bf16 v[40:55], v[72:75], v[4:7], v[8:23]
    ds_read_b128 v[72:75], v93 offset:16640
    v_exp_f32 v62, v62
    v_exp_f32 v63, v63
    v_exp_f32 v64, v64
    v_exp_f32 v65, v65
    v_exp_f32 v66, v66
    v_exp_f32 v67, v67
    v_smfmac_f32_32x32x32_bf16 v[24:39], v[84:87], v[56:63], v92
    s_waitcnt lgkmcnt(1)
    s_nop 0
    v_exp_f32 v68, v68
    v_exp_f32 v69, v69
    v_exp_f32 v70, v70
    v_exp_f32 v71, v71
    v_exp_f32 v40, v40
    v_exp_f32 v41, v41
    v_smfmac_f32_32x32x32_bf16 v[24:39], v[88:91], v[64:71], v92
    ds_read_b128 v[88:91], v95 offset:13760
    ds_read_b128 v[84:87], v94 offset:15584
    v_exp_f32 v42, v42
    v_exp_f32 v43, v43
    v_exp_f32 v44, v44
    v_exp_f32 v45, v45
    v_mfma_f32_32x32x16_bf16 v[56:71], v[76:79], v[4:7], v[8:23]
    ds_read_b128 v[76:79], v93 offset:18720
    v_exp_f32 v46, v46
    v_exp_f32 v47, v47
    v_exp_f32 v48, v48
    v_exp_f32 v49, v49
    v_exp_f32 v50, v50
    v_exp_f32 v51, v51
    v_smfmac_f32_32x32x32_bf16 v[24:39], v[80:83], v[40:47], v92
    s_waitcnt lgkmcnt(1)
    s_nop 0
    v_exp_f32 v52, v52
    v_exp_f32 v53, v53
    v_exp_f32 v54, v54
    v_exp_f32 v55, v55
    v_exp_f32 v56, v56
    v_exp_f32 v57, v57
    v_smfmac_f32_32x32x32_bf16 v[24:39], v[88:91], v[48:55], v92
    ds_read_b128 v[88:91], v95 offset:15840
    ds_read_b128 v[80:83], v94 offset:17664
    v_exp_f32 v58, v58
    v_exp_f32 v59, v59
    v_exp_f32 v60, v60
    v_exp_f32 v61, v61
    v_mfma_f32_32x32x16_bf16 v[40:55], v[72:75], v[4:7], v[8:23]
    ds_read_b128 v[72:75], v93 offset:20800
    v_exp_f32 v62, v62
    v_exp_f32 v63, v63
    v_exp_f32 v64, v64
    v_exp_f32 v65, v65
    v_exp_f32 v66, v66
    v_exp_f32 v67, v67
    v_smfmac_f32_32x32x32_bf16 v[24:39], v[84:87], v[56:63], v92
    s_waitcnt lgkmcnt(1)
    s_nop 0
    v_exp_f32 v68, v68
    v_exp_f32 v69, v69
    v_exp_f32 v70, v70
    v_exp_f32 v71, v71
    v_exp_f32 v40, v40
    v_exp_f32 v41, v41
    v_smfmac_f32_32x32x32_bf16 v[24:39], v[88:91], v[64:71], v92
    ds_read_b128 v[88:91], v95 offset:17920
    ds_read_b128 v[84:87], v94 offset:19744
    v_exp_f32 v42, v42
    v_exp_f32 v43, v43
    v_exp_f32 v44, v44
    v_exp_f32 v45, v45
    v_mfma_f32_32x32x16_bf16 v[56:71], v[76:79], v[4:7], v[8:23]
    ds_read_b128 v[76:79], v93 offset:22880
    v_exp_f32 v46, v46
    v_exp_f32 v47, v47
    v_exp_f32 v48, v48
    v_exp_f32 v49, v49
    v_exp_f32 v50, v50
    v_exp_f32 v51, v51
    v_smfmac_f32_32x32x32_bf16 v[24:39], v[80:83], v[40:47], v92
    s_waitcnt lgkmcnt(1)
    s_nop 0
    v_exp_f32 v52, v52
    v_exp_f32 v53, v53
    v_exp_f32 v54, v54
    v_exp_f32 v55, v55
    v_exp_f32 v56, v56
    v_exp_f32 v57, v57
    v_smfmac_f32_32x32x32_bf16 v[24:39], v[88:91], v[48:55], v92
    ds_read_b128 v[88:91], v95 offset:20000
    ds_read_b128 v[80:83], v94 offset:21824
    v_exp_f32 v58, v58
    v_exp_f32 v59, v59
    v_exp_f32 v60, v60
    v_exp_f32 v61, v61
    v_mfma_f32_32x32x16_bf16 v[40:55], v[72:75], v[4:7], v[8:23]
    ds_read_b128 v[72:75], v93 offset:24960
    v_exp_f32 v62, v62
    v_exp_f32 v63, v63
    v_exp_f32 v64, v64
    v_exp_f32 v65, v65
    v_exp_f32 v66, v66
    v_exp_f32 v67, v67
    v_smfmac_f32_32x32x32_bf16 v[24:39], v[84:87], v[56:63], v92
    s_waitcnt lgkmcnt(1)
    s_nop 0
    v_exp_f32 v68, v68
    v_exp_f32 v69, v69
    v_exp_f32 v70, v70
    v_exp_f32 v71, v71
    v_exp_f32 v40, v40
    v_exp_f32 v41, v41
    v_smfmac_f32_32x32x32_bf16 v[24:39], v[88:91], v[64:71], v92
    ds_read_b128 v[88:91], v95 offset:22080
    ds_read_b128 v[84:87], v94 offset:23904
    v_exp_f32 v42, v42
    v_exp_f32 v43, v43
    v_exp_f32 v44, v44
    v_exp_f32 v45, v45
    v_mfma_f32_32x32x16_bf16 v[56:71], v[76:79], v[4:7], v[8:23]
    ds_read_b128 v[76:79], v93 offset:27040
    v_exp_f32 v46, v46
    v_exp_f32 v47, v47
    v_exp_f32 v48, v48
    v_exp_f32 v49, v49
    v_exp_f32 v50, v50
    v_exp_f32 v51, v51
    v_smfmac_f32_32x32x32_bf16 v[24:39], v[80:83], v[40:47], v92
    s_waitcnt lgkmcnt(1)
    s_nop 0
    v_exp_f32 v52, v52
    v_exp_f32 v53, v53
    v_exp_f32 v54, v54
    v_exp_f32 v55, v55
    v_exp_f32 v56, v56
    v_exp_f32 v57, v57
    v_smfmac_f32_32x32x32_bf16 v[24:39], v[88:91], v[48:55], v92
    ds_read_b128 v[88:91], v95 offset:24160
    ds_read_b128 v[80:83], v94 offset:25984
    v_exp_f32 v58, v58
    v_exp_f32 v59, v59
    v_exp_f32 v60, v60
    v_exp_f32 v61, v61
    v_mfma_f32_32x32x16_bf16 v[40:55], v[72:75], v[4:7], v[8:23]
    ds_read_b128 v[72:75], v93 offset:29120
    v_exp_f32 v62, v62
    v_exp_f32 v63, v63
    v_exp_f32 v64, v64
    v_exp_f32 v65, v65
    v_exp_f32 v66, v66
    v_exp_f32 v67, v67
    v_smfmac_f32_32x32x32_bf16 v[24:39], v[84:87], v[56:63], v92
    s_waitcnt lgkmcnt(1)
    s_nop 0
    v_exp_f32 v68, v68
    v_exp_f32 v69, v69
    v_exp_f32 v70, v70
    v_exp_f32 v71, v71
    v_exp_f32 v40, v40
    v_exp_f32 v41, v41
    v_smfmac_f32_32x32x32_bf16 v[24:39], v[88:91], v[64:71], v92
    ds_read_b128 v[88:91], v95 offset:26240
    ds_read_b128 v[84:87], v94 offset:28064
    v_exp_f32 v42, v42
    v_exp_f32 v43, v43
    v_exp_f32 v44, v44
    v_exp_f32 v45, v45
    v_mfma_f32_32x32x16_bf16 v[56:71], v[76:79], v[4:7], v[8:23]
    ds_read_b128 v[76:79], v93 offset:31200
    v_exp_f32 v46, v46
    v_exp_f32 v47, v47
    v_exp_f32 v48, v48
    v_exp_f32 v49, v49
    v_exp_f32 v50, v50
    v_exp_f32 v51, v51
    v_smfmac_f32_32x32x32_bf16 v[24:39], v[80:83], v[40:47], v92
    s_waitcnt lgkmcnt(1)
    s_cmp_lg_u32 s9, 0
    v_exp_f32 v52, v52
    v_exp_f32 v53, v53
    v_exp_f32 v54, v54
    v_exp_f32 v55, v55
    s_cbranch_scc1 L_gated__rdy_18
L_gated__poll_19:
    ds_read_b32 v96, v99
    ds_read_b32 v97, v98 offset:64
    s_waitcnt lgkmcnt(0)
    v_readfirstlane_b32 s4, v96
    v_readfirstlane_b32 s5, v97
    s_cmp_lt_u32 s4, 4
    s_cbranch_scc1 L_gated__poll_19
    s_cmp_ge_u32 s5, 28
    s_cselect_b32 s9, 1, 0
    v_add_u32 v99, 4, v99
.p2align 3
L_gated__rdy_18:
    v_exp_f32 v56, v56
    v_exp_f32 v57, v57
    v_smfmac_f32_32x32x32_bf16 v[24:39], v[88:91], v[48:55], v92
    ds_read_b128 v[88:91], v95 offset:28320
    ds_read_b128 v[80:83], v94 offset:30144
    v_exp_f32 v58, v58
    v_exp_f32 v59, v59
    v_exp_f32 v60, v60
    v_exp_f32 v61, v61
    v_mfma_f32_32x32x16_bf16 v[40:55], v[72:75], v[4:7], v[8:23]
    ds_read_b128 v[72:75], v93 offset:33280
    v_exp_f32 v62, v62
    v_exp_f32 v63, v63
    v_exp_f32 v64, v64
    v_exp_f32 v65, v65
    v_exp_f32 v66, v66
    v_exp_f32 v67, v67
    v_smfmac_f32_32x32x32_bf16 v[24:39], v[84:87], v[56:63], v92
    s_waitcnt lgkmcnt(1)
    s_nop 0
    v_exp_f32 v68, v68
    v_exp_f32 v69, v69
    v_exp_f32 v70, v70
    v_exp_f32 v71, v71
    v_exp_f32 v40, v40
    v_exp_f32 v41, v41
    v_smfmac_f32_32x32x32_bf16 v[24:39], v[88:91], v[64:71], v92
    ds_read_b128 v[88:91], v95 offset:30400
    ds_read_b128 v[84:87], v94 offset:32224
    v_exp_f32 v42, v42
    v_exp_f32 v43, v43
    v_exp_f32 v44, v44
    v_exp_f32 v45, v45
    v_mfma_f32_32x32x16_bf16 v[56:71], v[76:79], v[4:7], v[8:23]
    ds_read_b128 v[76:79], v93 offset:35360
    v_exp_f32 v46, v46
    v_exp_f32 v47, v47
    v_exp_f32 v48, v48
    v_exp_f32 v49, v49
    v_exp_f32 v50, v50
    v_exp_f32 v51, v51
    v_smfmac_f32_32x32x32_bf16 v[24:39], v[80:83], v[40:47], v92
    s_waitcnt lgkmcnt(1)
    s_add_u32 s33, s33, 1
    v_exp_f32 v52, v52
    v_exp_f32 v53, v53
    v_exp_f32 v54, v54
    v_exp_f32 v55, v55
    v_exp_f32 v56, v56
    v_exp_f32 v57, v57
    v_smfmac_f32_32x32x32_bf16 v[24:39], v[88:91], v[48:55], v92
    ds_read_b128 v[88:91], v95 offset:32480
    ds_read_b128 v[80:83], v94 offset:34304
    v_exp_f32 v58, v58
    v_exp_f32 v59, v59
    v_exp_f32 v60, v60
    v_exp_f32 v61, v61
    v_mfma_f32_32x32x16_bf16 v[40:55], v[72:75], v[4:7], v[8:23]
    ds_read_b128 v[72:75], v93 offset:37440
    v_exp_f32 v62, v62
    v_exp_f32 v63, v63
    v_exp_f32 v64, v64
    v_exp_f32 v65, v65
    v_exp_f32 v66, v66
    v_exp_f32 v67, v67
    v_smfmac_f32_32x32x32_bf16 v[24:39], v[84:87], v[56:63], v92
    s_waitcnt lgkmcnt(1)
    s_cmp_lt_u32 s33, 4
    v_exp_f32 v68, v68
    v_exp_f32 v69, v69
    v_exp_f32 v70, v70
    v_exp_f32 v71, v71
    v_add_u32 v93, 33280, v93
    v_add_u32 v94, 33280, v94
    v_add_u32 v95, 33280, v95
    s_cbranch_scc1 L_a_loop
    v_smfmac_f32_32x32x32_bf16 v[24:39], v[88:91], v[64:71], v92
    s_waitcnt lgkmcnt(0)
    s_setprio 3
    s_nop 15
    s_cmp_lg_u32 s8, 0
    s_cbranch_scc1 L_a_fin
    v_max3_f32 v96, abs(v24), abs(v25), abs(v26)
    v_max3_f32 v96, v96, abs(v27), abs(v28)
    v_max3_f32 v96, v96, abs(v29), abs(v30)
    v_max_f32 v96, v96, abs(v31)
    v_add_f32 v97, v24, v25
    v_add_f32 v97, v97, v26
    v_add_f32 v97, v97, v27
    v_add_f32 v97, v97, v28
    v_add_f32 v97, v97, v29
    v_add_f32 v97, v97, v30
    v_add_f32 v97, v97, v31
    s_mov_b32 s4, 0x53800000
    s_mov_b32 s5, 0x7b800000
    v_cmp_gt_f32 vcc, s4, v32
    v_cmp_gt_f32 s[6:7], s5, v96
    v_cmp_o_f32 s[10:11], v97, v97
    s_and_b64 vcc, vcc, s[6:7]
    s_and_b64 vcc, vcc, s[10:11]
    s_cmp_eq_u64 vcc, exec
    s_cbranch_scc1 L_a_fin
    s_mov_b32 s8, 1
    s_mov_b32 s9, 1
    v_mov_b32 v93, v100
    v_mov_b32 v96, 0xff800000
    s_mov_b32 s33, 0
L_a_maxloop:
    ds_read_b128 v[72:75], v93
    s_waitcnt lgkmcnt(0)
    v_mfma_f32_32x32x16_bf16 v[40:55], v[72:75], v[4:7], 0
    v_add_u32 v93, 2080, v93
    s_nop 15
    v_max3_f32 v96, v96, v40, v41
    v_max3_f32 v96, v96, v42, v43
    v_max3_f32 v96, v96, v44, v45
    v_max3_f32 v96, v96, v46, v47
    v_max3_f32 v96, v96, v48, v49
    v_max3_f32 v96, v96, v50, v51
    v_max3_f32 v96, v96, v52, v53
    v_max3_f32 v96, v96, v54, v55
    s_add_u32 s33, s33, 1
    s_cmp_lt_u32 s33, 64
    s_cbranch_scc1 L_a_maxloop
    s_branch L_a_setmax
L_a_fin:
    v_rcp_f32 v96, v32
    s_mov_b64 exec, 1
    ds_add_u32 v98, v101 offset:80
    s_mov_b64 exec, -1
    s_lshr_b32 s4, s27, 1
    s_lshl_b32 s4, s4, 6
    s_lshl_b32 s5, s26, 1
    s_add_u32 s4, s4, s5
    s_and_b32 s5, s27, 1
    s_add_u32 s4, s4, s5
    s_lshl_b32 s30, s4, 10
    s_add_u32 s30, s30, 10485760
    s_lshl_b32 s31, s4, 7
    s_add_u32 s31, s31, 13107200
    v_mul_f32 v24, v24, v96
    v_mul_f32 v25, v25, v96
    v_mul_f32 v26, v26, v96
    v_mul_f32 v27, v27, v96
    v_mul_f32 v28, v28, v96
    v_mul_f32 v29, v29, v96
    v_mul_f32 v30, v30, v96
    v_mul_f32 v31, v31, v96
    v_cvt_pk_bf16_f32 v72, v24, v25
    v_cvt_pk_bf16_f32 v73, v26, v27
    v_cvt_pk_bf16_f32 v74, v28, v29
    v_cvt_pk_bf16_f32 v75, v30, v31
    buffer_store_dwordx4 v[72:75], v100, s[20:23], s30 offen sc1
    v_lshlrev_b32 v96, 2, v2
    v_mov_b32 v97, s35
    s_waitcnt vmcnt(0)
    s_mov_b32 exec_hi, 0
    buffer_store_dword v97, v96, s[20:23], s31 offen sc1
    s_mov_b64 exec, -1
    s_lshl_b32 s26, s24, 2
    s_lshr_b32 s27, s25, 3
    s_add_u32 s26, s26, s27
    s_and_b32 s27, s25, 7
    s_mov_b32 s12, s40
    s_and_b32 s13, s41, 0xffff
    s_mov_b32 s14, 0x80000
    s_mov_b32 s15, 0x00020000
    v_lshrrev_b32 v5, 3, v2
    v_mul_u32_u24 v4, 1024, v5
    v_bfe_u32 v5, v2, 4, 1
    v_lshlrev_b32 v5, 2, v5
    v_and_b32 v6, 7, v2
    v_xor_b32 v5, v5, v6
    v_lshl_add_u32 v4, v5, 4, v4
    s_lshl_b32 s30, s3, 14
    s_lshl_b32 s28, s26, 16
    s_lshl_b32 s4, s3, 13
    s_add_u32 s28, s28, s4
    s_add_u32 s28, s28, 10485760
    s_lshl_b32 s29, s3, 16
    s_lshl_b32 s31, s27, 7
    s_add_u32 s29, s29, s31
    s_lshl_b32 s33, s26, 13
    s_lshl_b32 s4, s3, 10
    s_add_u32 s33, s33, s4
    s_add_u32 s33, s33, 13107200
    v_and_b32 v97, 7, v2
    v_lshlrev_b32 v97, 7, v97
    s_lshl_b32 s4, 1, s3
    v_mov_b32 v101, s4
L_gated__lw_20:
    ds_read_b32 v96, v98 offset:80
    s_waitcnt lgkmcnt(0)
    v_readfirstlane_b32 s4, v96
    s_cmp_ge_u32 s4, 12
    s_cbranch_scc1 L_gated__lwd_21
    s_sleep 2
    s_branch L_gated__lw_20
L_gated__lwd_21:
    s_add_u32 m0, s30, 8192
    s_add_u32 s31, s29, 0
    buffer_load_dwordx4 v4, s[12:15], s31 offen lds
    s_add_u32 m0, s30, 9216
    s_add_u32 s31, s29, 8192
    buffer_load_dwordx4 v4, s[12:15], s31 offen lds
    s_add_u32 m0, s30, 10240
    s_add_u32 s31, s29, 16384
    buffer_load_dwordx4 v4, s[12:15], s31 offen lds
    s_add_u32 m0, s30, 11264
    s_add_u32 s31, s29, 24576
    buffer_load_dwordx4 v4, s[12:15], s31 offen lds
    s_add_u32 m0, s30, 12288
    s_add_u32 s31, s29, 32768
    buffer_load_dwordx4 v4, s[12:15], s31 offen lds
    s_add_u32 m0, s30, 13312
    s_add_u32 s31, s29, 40960
    buffer_load_dwordx4 v4, s[12:15], s31 offen lds
    s_add_u32 m0, s30, 14336
    s_add_u32 s31, s29, 49152
    buffer_load_dwordx4 v4, s[12:15], s31 offen lds
    s_add_u32 m0, s30, 15360
    s_add_u32 s31, s29, 57344
    buffer_load_dwordx4 v4, s[12:15], s31 offen lds
    s_mov_b64 exec, 0xff
    s_mov_b32 s5, 0
L_gated__fp_22:
    buffer_load_dword v96, v97, s[20:23], s33 offen sc1
    s_add_u32 s5, s5, 1
    s_waitcnt vmcnt(0)
    v_cmp_ne_u32 vcc, s35, v96
    s_and_b64 exec, exec, vcc
    s_cbranch_scc0 L_gated__fpd_23
    s_sleep 2
    s_cmp_lt_u32 s5, 262144
    s_cbranch_scc1 L_gated__fp_22
L_gated__fpd_23:
    s_mov_b64 exec, -1
    s_add_u32 m0, s30, 0
    s_add_u32 s31, s28, 0
    buffer_load_dwordx4 v100, s[20:23], s31 offen offset:0 sc1 lds
    buffer_load_dwordx4 v100, s[20:23], s31 offen offset:1024 sc1 lds
    buffer_load_dwordx4 v100, s[20:23], s31 offen offset:2048 sc1 lds
    buffer_load_dwordx4 v100, s[20:23], s31 offen offset:3072 sc1 lds
    s_add_u32 m0, s30, 4096
    s_add_u32 s31, s28, 4096
    buffer_load_dwordx4 v100, s[20:23], s31 offen offset:0 sc1 lds
    buffer_load_dwordx4 v100, s[20:23], s31 offen offset:1024 sc1 lds
    buffer_load_dwordx4 v100, s[20:23], s31 offen offset:2048 sc1 lds
    buffer_load_dwordx4 v100, s[20:23], s31 offen offset:3072 sc1 lds
    s_waitcnt vmcnt(0)
    s_mov_b64 exec, 1
    ds_add_u32 v98, v101 offset:96
    s_mov_b64 exec, -1
    s_endpgm
L_m_start:
    s_sub_u32 s33, s3, 8
    v_lshlrev_b32 v14, 4, v2
    v_mov_b32 v8, 157696
    v_mov_b32 v9, 1
    v_mov_b32 v15, 0
    v_mov_b32 v140, 0
    s_cmp_lg_u32 s33, 0
    s_cbranch_scc1 L_m_i2
    v_lshlrev_b32 v136, 2, v2
    v_add_u32 v136, 157696, v136
    v_cmp_eq_u32 vcc, 8, v2
    v_mov_b32 v138, 4
    s_nop 0
    v_cndmask_b32 v138, 0, v138, vcc
    ds_write_b32 v136, v138
L_m_i2:
    s_waitcnt lgkmcnt(0)
    s_mov_b32 s60, s56
    s_and_b32 s61, s57, 0xffff
    s_mov_b32 s62, 0x100
    s_mov_b32 s63, 0x00020000
    s_cmp_lg_u32 s33, 1
    s_cbranch_scc1 L_m_i1
    s_cmp_lg_u32 s2, 0
    s_cbranch_scc1 L_m_i1
    s_memrealtime s[4:5]
    s_waitcnt lgkmcnt(0)
    s_or_b32 s4, s4, 1
    v_mov_b32 v138, s4
    s_mov_b64 exec, 1
    buffer_store_dword v138, v15, s[60:63], 0 offen sc1
    s_mov_b64 exec, -1
L_m_i1:
    s_cmp_lt_u32 s25, 24
    s_cbranch_scc1 L_m_e1
    s_mov_b32 s12, s44
    s_and_b32 s13, s45, 0xffff
    s_mov_b32 s14, 0x560000
    s_mov_b32 s15, 0x00020000
    s_lshr_b32 s4, s24, 1
    s_lshl_b32 s4, s4, 3
    s_add_u32 s4, s4, s25
    s_sub_u32 s4, s4, 24
    s_lshl_b32 s4, s4, 2
    s_add_u32 s4, s4, s33
    s_mul_i32 s43, s4, 44032
    s_and_b32 s5, s24, 1
    s_mul_i32 s5, s5, 1344
    s_add_u32 s43, s43, s5
    v_lshrrev_b32 v140, 4, v2
    v_mul_u32_u24 v140, 2752, v140
    v_and_b32 v141, 15, v2
    v_lshlrev_b32 v141, 7, v141
    v_min_u32 v141, 1532, v141
    v_add_u32 v140, v140, v141
    s_add_u32 s11, s43, 0
    buffer_load_dword v141, v140, s[12:15], s11 offen
    s_add_u32 s11, s43, 11008
    buffer_load_dword v141, v140, s[12:15], s11 offen
L_m_e1:
    s_barrier
    s_cmp_lg_u32 s33, 1
    s_cbranch_scc1 L_m_i3
    buffer_load_dword v136, v15, s[60:63], 0 offen sc1
L_m_i3:
    s_mul_i32 s30, s33, 6144
    s_add_u32 s30, s30, 133120
    s_mov_b32 s34, 0
    v_add_u32 v13, s30, v14
    s_lshr_b32 s8, s33, 1
    s_and_b32 s9, s33, 1
    s_xor_b32 s31, s33, 1
    s_mul_i32 s31, s31, 6144
    s_add_u32 s31, s31, 133120
    v_add_u32 v10, s31, v14
    s_xor_b32 s31, s33, 2
    s_mul_i32 s31, s31, 6144
    s_add_u32 s31, s31, 133120
    v_add_u32 v11, s31, v14
    s_xor_b32 s31, s33, 3
    s_mul_i32 s31, s31, 6144
    s_add_u32 s31, s31, 133120
    v_add_u32 v12, s31, v14
    s_mov_b32 s20, s58
    s_and_b32 s21, s59, 0xffff
    s_mov_b32 s22, 0x10000000
    s_mov_b32 s23, 0x00020000
    s_mov_b32 s12, s44
    s_and_b32 s13, s45, 0xffff
    s_mov_b32 s14, 0x560000
    s_mov_b32 s15, 0x00020000
    s_mov_b32 s16, s46
    s_and_b32 s17, s47, 0xffff
    s_mov_b32 s18, 0xac0
    s_mov_b32 s19, 0x00020000
    s_cmp_ge_u32 s25, 24
    s_cbranch_scc1 L_m_i4
    s_barrier
    s_barrier
L_m_i4:
    s_cmp_lg_u32 s33, 1
    s_cbranch_scc1 L_m_i5
    s_mov_b32 s5, 0
    s_waitcnt vmcnt(0)
L_m_tag:
    v_readfirstlane_b32 s4, v136
    s_cmp_lg_u32 s4, 0
    s_cbranch_scc1 L_m_tagok
    buffer_load_dword v136, v15, s[60:63], 0 offen sc1
    s_add_u32 s5, s5, 1
    s_cmp_lt_u32 s5, 262144
    s_waitcnt vmcnt(0)
    s_cbranch_scc1 L_m_tag
L_m_tagok:
    ds_write_b32 v8, v136 offset:76
    s_waitcnt lgkmcnt(0)
L_m_i5:
    s_barrier
    ds_read_b32 v128, v8 offset:76
    s_waitcnt lgkmcnt(0)
    v_readfirstlane_b32 s35, v128
    s_nop 1
    s_mov_b32 s60, s48
    s_and_b32 s61, s49, 0xffff
    s_mov_b32 s62, 0x560000
    s_mov_b32 s63, 0x00020000
    s_and_b32 s26, s24, 1
    s_mul_i32 s26, s26, 30
    s_add_u32 s26, s26, s25
    s_and_b32 s27, s26, 3
    s_lshr_b32 s26, s26, 2
    s_lshr_b32 s6, s24, 1
    s_lshl_b32 s28, s27, 1
    s_add_u32 s28, s28, s8
    s_lshl_b32 s28, s28, 18
    s_lshl_b32 s29, s6, 16
    s_add_u32 s28, s28, s29
    s_lshl_b32 s29, s9, 10
    s_add_u32 s28, s28, s29
    s_add_u32 s28, s28, 6291456
    s_lshl_b32 s29, s6, 5
    s_add_u32 s29, s29, s33
    s_mul_i32 s29, s29, 44032
    s_mul_i32 s7, s26, 192
    s_add_u32 s29, s29, s7
    s_lshl_b32 s32, s27, 1
    s_add_u32 s32, s32, s26
    s_and_b32 s32, s32, 7
    s_mul_i32 s7, s33, 3072
    s_add_u32 s7, s7, 133120
    v_add_u32 v7, 4096, v14
    v_lshrrev_b32 v128, 5, v2
    v_bfe_u32 v129, v2, 2, 2
    v_lshl_add_u32 v129, v128, 3, v129
    v_mul_u32_u24 v6, 192, v129
    v_bfe_u32 v129, v2, 4, 1
    v_lshl_add_u32 v6, v129, 5, v6
    v_and_b32 v129, 3, v2
    v_lshl_add_u32 v6, v129, 3, v6
    v_add_u32 v6, 133120, v6
    v_add_u32 v128, 0, v2
    v_mul_u32_u24 v129, 43691, v128
    v_lshrrev_b32 v129, 19, v129
    v_mul_u32_u24 v130, 12, v129
    v_sub_u32 v128, v128, v130
    v_mul_u32_u24 v129, 2752, v129
    v_lshl_add_u32 v3, v128, 4, v129
    v_add_u32 v128, 64, v2
    v_mul_u32_u24 v129, 43691, v128
    v_lshrrev_b32 v129, 19, v129
    v_mul_u32_u24 v130, 12, v129
    v_sub_u32 v128, v128, v130
    v_mul_u32_u24 v129, 2752, v129
    v_lshl_add_u32 v4, v128, 4, v129
    v_add_u32 v128, 128, v2
    v_mul_u32_u24 v129, 43691, v128
    v_lshrrev_b32 v129, 19, v129
    v_mul_u32_u24 v130, 12, v129
    v_sub_u32 v128, v128, v130
    v_mul_u32_u24 v129, 2752, v129
    v_lshl_add_u32 v5, v128, 4, v129
    s_lshl_b32 s31, s6, 11
    s_add_u32 s31, s31, 13631488
    v_and_b32 v15, 15, v2
    v_lshlrev_b32 v15, 7, v15
    v_mov_b32 v16, 0
    v_mov_b32 v17, 0
    v_mov_b32 v18, 0
    v_mov_b32 v19, 0
    v_mov_b32 v20, 0
    v_mov_b32 v21, 0
    v_mov_b32 v22, 0
    v_mov_b32 v23, 0
    v_mov_b32 v24, 0
    v_mov_b32 v25, 0
    v_mov_b32 v26, 0
    v_mov_b32 v27, 0
    v_mov_b32 v28, 0
    v_mov_b32 v29, 0
    v_mov_b32 v30, 0
    v_mov_b32 v31, 0
    v_mov_b32 v32, 0
    v_mov_b32 v33, 0
    v_mov_b32 v34, 0
    v_mov_b32 v35, 0
    v_mov_b32 v36, 0
    v_mov_b32 v37, 0
    v_mov_b32 v38, 0
    v_mov_b32 v39, 0
    v_mov_b32 v40, 0
    v_mov_b32 v41, 0
    v_mov_b32 v42, 0
    v_mov_b32 v43, 0
    v_mov_b32 v44, 0
    v_mov_b32 v45, 0
    v_mov_b32 v46, 0
    v_mov_b32 v47, 0
    v_mov_b32 v48, 0
    v_mov_b32 v49, 0
    v_mov_b32 v50, 0
    v_mov_b32 v51, 0
    v_mov_b32 v52, 0
    v_mov_b32 v53, 0
    v_mov_b32 v54, 0
    v_mov_b32 v55, 0
    v_mov_b32 v56, 0
    v_mov_b32 v57, 0
    v_mov_b32 v58, 0
    v_mov_b32 v59, 0
    v_mov_b32 v60, 0
    v_mov_b32 v61, 0
    v_mov_b32 v62, 0
    v_mov_b32 v63, 0
    s_cmp_ge_u32 s25, 30
    s_cbranch_scc1 L_m_nc
    s_lshl_b32 s11, s27, 4
    s_add_u32 s11, s11, s26
    s_lshl_b32 s11, s11, 2
    s_add_u32 s11, s11, s33
    s_lshl_b32 s11, s11, 2
    s_add_u32 s11, s11, s6
    s_lshl_b32 s11, s11, 7
    s_add_u32 s11, s11, 13369344
    v_lshlrev_b32 v138, 2, v2
    v_mov_b32 v139, 0
    s_mov_b32 exec_hi, 0
    buffer_store_dword v139, v138, s[20:23], s11 offen sc1
    s_mov_b64 exec, -1
    s_mul_i32 s4, s26, 3
    s_add_u32 s4, s4, s33
    s_cmp_eq_u32 s33, 3
    s_cbranch_scc1 L_m_nc
    s_cmp_ge_u32 s4, 44
    s_cbranch_scc1 L_m_nc
    s_lshl_b32 s10, s27, 1
    s_lshr_b32 s5, s6, 1
    s_add_u32 s10, s10, s5
    s_lshl_b32 s10, s10, 14
    s_lshl_b32 s4, s4, 8
    s_add_u32 s10, s10, s4
    s_and_b32 s5, s6, 1
    s_lshl_b32 s5, s5, 7
    s_add_u32 s10, s10, s5
    s_add_u32 s10, s10, 12779520
    v_lshlrev_b32 v138, 2, v2
    v_mov_b32 v139, 0
    s_mov_b32 exec_hi, 0
    buffer_store_dword v139, v138, s[20:23], s10 offen sc1
    s_mov_b64 exec, -1
L_m_nc:
    s_cmp_lt_u32 s25, 24
    s_cbranch_scc1 L_m_q
    s_sub_u32 s42, s25, 24
    s_add_u32 s11, s43, 22016
    buffer_load_dword v141, v140, s[12:15], s11 offen
    s_add_u32 s11, s43, 33024
    buffer_load_dword v141, v140, s[12:15], s11 offen
    s_cmp_lg_u32 s33, 0
    s_cbranch_scc1 L_m_nofhh
    s_mov_b32 s5, 0
L_gated__fp_24:
    buffer_load_dword v128, v15, s[20:23], s31 offen sc1
    s_add_u32 s5, s5, 1
    s_waitcnt vmcnt(0)
    v_cmp_ne_u32 vcc, s35, v128
    s_and_b64 exec, exec, vcc
    s_cbranch_scc0 L_gated__fpd_25
    s_sleep 2
    s_cmp_lt_u32 s5, 262144
    s_cbranch_scc1 L_gated__fp_24
L_gated__fpd_25:
    s_mov_b64 exec, -1
    s_mov_b64 exec, 1
    ds_add_u32 v8, v9 offset:128
    s_mov_b64 exec, -1
L_m_nofhh:
L_gated__lw_26:
    ds_read_b32 v128, v8 offset:128
    s_waitcnt lgkmcnt(0)
    v_readfirstlane_b32 s4, v128
    s_cmp_ge_u32 s4, 1
    s_cbranch_scc1 L_gated__lwd_27
    s_sleep 1
    s_branch L_gated__lw_26
L_gated__lwd_27:
    s_lshl_b32 s10, s42, 18
    s_lshl_b32 s4, s6, 16
    s_add_u32 s10, s10, s4
    s_lshl_b32 s4, s33, 14
    s_add_u32 s10, s10, s4
    s_add_u32 s10, s10, 6291456
    s_add_u32 s11, s10, 8192
    v_lshlrev_b32 v142, 7, v2
    buffer_load_dword v141, v142, s[20:23], s10 offen sc1
    buffer_load_dword v141, v142, s[20:23], s11 offen sc1
    s_waitcnt vmcnt(0)
    s_setprio 3
    s_mov_b64 exec, 1
    ds_add_u32 v8, v9 offset:88
    s_mov_b64 exec, -1
    s_cmp_lt_u32 s25, 30
    s_cbranch_scc1 L_m_hg1
L_gated__lw_28:
    ds_read_b32 v128, v8 offset:64
    s_waitcnt lgkmcnt(0)
    v_readfirstlane_b32 s4, v128
    s_cmp_ge_u32 s4, 28
    s_cbranch_scc1 L_gated__lwd_29
    s_sleep 3
    s_branch L_gated__lw_28
L_gated__lwd_29:
    v_lshrrev_b32 v142, 2, v2
    v_and_b32 v143, 3, v2
    v_lshlrev_b32 v142, 12, v142
    v_lshl_add_u32 v142, v143, 7, v142
    s_sub_u32 s42, s25, 30
    s_mul_i32 s43, s33, 22
    s_add_u32 s42, s42, s43
    s_lshl_b32 s42, s42, 16
    s_lshl_b32 s4, s24, 9
    s_add_u32 s42, s42, s4
    s_mov_b32 s43, 0
L_m_w2l:
    buffer_load_dword v141, v142, s[60:63], s42 offen
    s_add_u32 s42, s42, 131072
    s_add_u32 s43, s43, 1
    s_cmp_lt_u32 s43, 11
    s_cbranch_scc1 L_m_w2l
    s_branch L_m_skipred
L_m_q:
    s_barrier
    s_barrier
    s_barrier
    s_barrier
    s_barrier
    s_setprio 3
L_gated__lw_30:
    ds_read_b32 v128, v8 offset:156
    s_waitcnt lgkmcnt(0)
    v_readfirstlane_b32 s4, v128
    s_cmp_ge_u32 s4, 4
    s_cbranch_scc1 L_gated__lwd_31
    s_sleep 1
    s_branch L_gated__lw_30
L_gated__lwd_31:
    s_cmp_lg_u32 s33, 0
    s_cbranch_scc1 L_m_nofhq
    s_mov_b32 s5, 0
L_gated__fp_32:
    buffer_load_dword v128, v15, s[20:23], s31 offen sc1
    s_add_u32 s5, s5, 1
    s_waitcnt vmcnt(0)
    v_cmp_ne_u32 vcc, s35, v128
    s_and_b64 exec, exec, vcc
    s_cbranch_scc0 L_gated__fpd_33
    s_sleep 2
    s_cmp_lt_u32 s5, 262144
    s_cbranch_scc1 L_gated__fp_32
L_gated__fpd_33:
    s_mov_b64 exec, -1
    s_mov_b64 exec, 1
    ds_add_u32 v8, v9 offset:128
    s_mov_b64 exec, -1
L_m_nofhq:
L_gated__lw_34:
    ds_read_b32 v128, v8 offset:128
    s_waitcnt lgkmcnt(0)
    v_readfirstlane_b32 s4, v128
    s_cmp_ge_u32 s4, 1
    s_cbranch_scc1 L_gated__lwd_35
    s_sleep 1
    s_branch L_gated__lw_34
L_gated__lwd_35:
L_m_hg1:
    s_xor_b32 s11, s32, 0
    s_mul_i32 s11, s11, 176128
    s_add_u32 s11, s11, s29
    s_add_u32 m0, s7, 0
    s_nop 0
    buffer_load_dwordx4 v3, s[12:15], s11 offen lds
    s_add_u32 m0, s7, 1024
    s_nop 0
    buffer_load_dwordx4 v4, s[12:15], s11 offen lds
    s_add_u32 m0, s7, 2048
    s_nop 0
    buffer_load_dwordx4 v5, s[12:15], s11 offen lds
    s_xor_b32 s10, s32, 0
    s_lshl_b32 s10, s10, 13
    s_add_u32 s10, s10, s28
    buffer_load_dwordx4 v[80:83], v14, s[20:23], s10 offen offset:0 sc1
    buffer_load_dwordx4 v[84:87], v14, s[20:23], s10 offen offset:2048 sc1
    buffer_load_dwordx4 v[88:91], v7, s[20:23], s10 offen offset:0 sc1
    buffer_load_dwordx4 v[92:95], v7, s[20:23], s10 offen offset:2048 sc1
    s_xor_b32 s10, s32, 1
    s_lshl_b32 s10, s10, 13
    s_add_u32 s10, s10, s28
    buffer_load_dwordx4 v[96:99], v14, s[20:23], s10 offen offset:0 sc1
    buffer_load_dwordx4 v[100:103], v14, s[20:23], s10 offen offset:2048 sc1
    buffer_load_dwordx4 v[104:107], v7, s[20:23], s10 offen offset:0 sc1
    buffer_load_dwordx4 v[108:111], v7, s[20:23], s10 offen offset:2048 sc1
    s_waitcnt vmcnt(4)
    s_mov_b64 exec, 1
    ds_add_u32 v8, v9 offset:68
    s_mov_b64 exec, -1
    s_add_u32 s34, s34, 4
    s_setprio 3
L_gated__mbw_36:
    ds_read_b32 v136, v8 offset:68
    s_waitcnt lgkmcnt(0)
    v_readfirstlane_b32 s4, v136
    s_cmp_ge_u32 s4, s34
    s_cbranch_scc1 L_gated__mbw_36d
    s_sleep 1
    s_branch L_gated__mbw_36
L_gated__mbw_36d:
    s_setprio 0
    ds_read_b64_tr_b16 v[112:113], v6 offset:0
    ds_read_b64_tr_b16 v[114:115], v6 offset:768
    ds_read_b64_tr_b16 v[116:117], v6 offset:64
    ds_read_b64_tr_b16 v[118:119], v6 offset:832
    ds_read_b64_tr_b16 v[120:121], v6 offset:128
    ds_read_b64_tr_b16 v[122:123], v6 offset:896
    s_xor_b32 s11, s32, 1
    s_mul_i32 s11, s11, 176128
    s_add_u32 s11, s11, s29
    s_add_u32 m0, s7, 12288
    s_nop 0
    buffer_load_dwordx4 v3, s[12:15], s11 offen lds
    s_add_u32 m0, s7, 13312
    s_nop 0
    buffer_load_dwordx4 v4, s[12:15], s11 offen lds
    s_add_u32 m0, s7, 14336
    s_nop 0
    buffer_load_dwordx4 v5, s[12:15], s11 offen lds
    s_xor_b32 s10, s32, 2
    s_lshl_b32 s10, s10, 13
    s_add_u32 s10, s10, s28
    s_waitcnt lgkmcnt(4)
    v_mfma_f32_32x32x16_bf16 v[16:31], v[112:115], v[80:83], v[16:31]
    ds_read_b64_tr_b16 v[124:125], v6 offset:3072
    ds_read_b64_tr_b16 v[126:127], v6 offset:3840
    s_waitcnt lgkmcnt(4)
    v_mfma_f32_32x32x16_bf16 v[32:47], v[116:119], v[80:83], v[32:47]
    ds_read_b64_tr_b16 v[128:129], v6 offset:3136
    ds_read_b64_tr_b16 v[130:131], v6 offset:3904
    s_waitcnt lgkmcnt(4)
    v_mfma_f32_32x32x16_bf16 v[48:63], v[120:123], v[80:83], v[48:63]
    ds_read_b64_tr_b16 v[132:133], v6 offset:3200
    ds_read_b64_tr_b16 v[134:135], v6 offset:3968
    buffer_load_dwordx4 v[80:83], v14, s[20:23], s10 offen offset:0 sc1
    s_waitcnt lgkmcnt(4)
    v_mfma_f32_32x32x16_bf16 v[16:31], v[124:127], v[84:87], v[16:31]
    ds_read_b64_tr_b16 v[112:113], v6 offset:6144
    ds_read_b64_tr_b16 v[114:115], v6 offset:6912
    s_waitcnt lgkmcnt(4)
    v_mfma_f32_32x32x16_bf16 v[32:47], v[128:131], v[84:87], v[32:47]
    ds_read_b64_tr_b16 v[116:117], v6 offset:6208
    ds_read_b64_tr_b16 v[118:119], v6 offset:6976
    s_waitcnt lgkmcnt(4)
    v_mfma_f32_32x32x16_bf16 v[48:63], v[132:135], v[84:87], v[48:63]
    ds_read_b64_tr_b16 v[120:121], v6 offset:6272
    ds_read_b64_tr_b16 v[122:123], v6 offset:7040
    buffer_load_dwordx4 v[84:87], v14, s[20:23], s10 offen offset:2048 sc1
    s_waitcnt lgkmcnt(4)
    v_mfma_f32_32x32x16_bf16 v[16:31], v[112:115], v[88:91], v[16:31]
    ds_read_b64_tr_b16 v[124:125], v6 offset:9216
    ds_read_b64_tr_b16 v[126:127], v6 offset:9984
    s_waitcnt lgkmcnt(4)
    v_mfma_f32_32x32x16_bf16 v[32:47], v[116:119], v[88:91], v[32:47]
    ds_read_b64_tr_b16 v[128:129], v6 offset:9280
    ds_read_b64_tr_b16 v[130:131], v6 offset:10048
    s_waitcnt lgkmcnt(4)
    v_mfma_f32_32x32x16_bf16 v[48:63], v[120:123], v[88:91], v[48:63]
    ds_read_b64_tr_b16 v[132:133], v6 offset:9344
    ds_read_b64_tr_b16 v[134:135], v6 offset:10112
    buffer_load_dwordx4 v[88:91], v7, s[20:23], s10 offen offset:0 sc1
    s_waitcnt vmcnt(3) lgkmcnt(0)
    s_mov_b64 exec, 1
    ds_add_u32 v8, v9 offset:68
    s_mov_b64 exec, -1
    s_add_u32 s34, s34, 4
    v_mfma_f32_32x32x16_bf16 v[16:31], v[124:127], v[92:95], v[16:31]
    v_mfma_f32_32x32x16_bf16 v[32:47], v[128:131], v[92:95], v[32:47]
    v_mfma_f32_32x32x16_bf16 v[48:63], v[132:135], v[92:95], v[48:63]
    buffer_load_dwordx4 v[92:95], v7, s[20:23], s10 offen offset:2048 sc1
    s_setprio 3
L_gated__mbw_37:
    ds_read_b32 v136, v8 offset:68
    s_waitcnt lgkmcnt(0)
    v_readfirstlane_b32 s4, v136
    s_cmp_ge_u32 s4, s34
    s_cbranch_scc1 L_gated__mbw_37d
    s_sleep 1
    s_branch L_gated__mbw_37
L_gated__mbw_37d:
    s_setprio 0
    ds_read_b64_tr_b16 v[112:113], v6 offset:12288
    ds_read_b64_tr_b16 v[114:115], v6 offset:13056
    ds_read_b64_tr_b16 v[116:117], v6 offset:12352
    ds_read_b64_tr_b16 v[118:119], v6 offset:13120
    ds_read_b64_tr_b16 v[120:121], v6 offset:12416
    ds_read_b64_tr_b16 v[122:123], v6 offset:13184
    s_xor_b32 s11, s32, 2
    s_mul_i32 s11, s11, 176128
    s_add_u32 s11, s11, s29
    s_add_u32 m0, s7, 0
    s_nop 0
    buffer_load_dwordx4 v3, s[12:15], s11 offen lds
    s_add_u32 m0, s7, 1024
    s_nop 0
    buffer_load_dwordx4 v4, s[12:15], s11 offen lds
    s_add_u32 m0, s7, 2048
    s_nop 0
    buffer_load_dwordx4 v5, s[12:15], s11 offen lds
    s_xor_b32 s10, s32, 3
    s_lshl_b32 s10, s10, 13
    s_add_u32 s10, s10, s28
    s_waitcnt lgkmcnt(4)
    v_mfma_f32_32x32x16_bf16 v[16:31], v[112:115], v[96:99], v[16:31]
    ds_read_b64_tr_b16 v[124:125], v6 offset:15360
    ds_read_b64_tr_b16 v[126:127], v6 offset:16128
    s_waitcnt lgkmcnt(4)
    v_mfma_f32_32x32x16_bf16 v[32:47], v[116:119], v[96:99], v[32:47]
    ds_read_b64_tr_b16 v[128:129], v6 offset:15424
    ds_read_b64_tr_b16 v[130:131], v6 offset:16192
    s_waitcnt lgkmcnt(4)
    v_mfma_f32_32x32x16_bf16 v[48:63], v[120:123], v[96:99], v[48:63]
    ds_read_b64_tr_b16 v[132:133], v6 offset:15488
    ds_read_b64_tr_b16 v[134:135], v6 offset:16256
    buffer_load_dwordx4 v[96:99], v14, s[20:23], s10 offen offset:0 sc1
    s_waitcnt lgkmcnt(4)
    v_mfma_f32_32x32x16_bf16 v[16:31], v[124:127], v[100:103], v[16:31]
    ds_read_b64_tr_b16 v[112:113], v6 offset:18432
    ds_read_b64_tr_b16 v[114:115], v6 offset:19200
    s_waitcnt lgkmcnt(4)
    v_mfma_f32_32x32x16_bf16 v[32:47], v[128:131], v[100:103], v[32:47]
    ds_read_b64_tr_b16 v[116:117], v6 offset:18496
    ds_read_b64_tr_b16 v[118:119], v6 offset:19264
    s_waitcnt lgkmcnt(4)
    v_mfma_f32_32x32x16_bf16 v[48:63], v[132:135], v[100:103], v[48:63]
    ds_read_b64_tr_b16 v[120:121], v6 offset:18560
    ds_read_b64_tr_b16 v[122:123], v6 offset:19328
    buffer_load_dwordx4 v[100:103], v14, s[20:23], s10 offen offset:2048 sc1
    s_waitcnt lgkmcnt(4)
    v_mfma_f32_32x32x16_bf16 v[16:31], v[112:115], v[104:107], v[16:31]
    ds_read_b64_tr_b16 v[124:125], v6 offset:21504
    ds_read_b64_tr_b16 v[126:127], v6 offset:22272
    s_waitcnt lgkmcnt(4)
    v_mfma_f32_32x32x16_bf16 v[32:47], v[116:119], v[104:107], v[32:47]
    ds_read_b64_tr_b16 v[128:129], v6 offset:21568
    ds_read_b64_tr_b16 v[130:131], v6 offset:22336
    s_waitcnt lgkmcnt(4)
    v_mfma_f32_32x32x16_bf16 v[48:63], v[120:123], v[104:107], v[48:63]
    ds_read_b64_tr_b16 v[132:133], v6 offset:21632
    ds_read_b64_tr_b16 v[134:135], v6 offset:22400
    buffer_load_dwordx4 v[104:107], v7, s[20:23], s10 offen offset:0 sc1
    s_waitcnt vmcnt(3) lgkmcnt(0)
    s_mov_b64 exec, 1
    ds_add_u32 v8, v9 offset:68
    s_mov_b64 exec, -1
    s_add_u32 s34, s34, 4
    v_mfma_f32_32x32x16_bf16 v[16:31], v[124:127], v[108:111], v[16:31]
    v_mfma_f32_32x32x16_bf16 v[32:47], v[128:131], v[108:111], v[32:47]
    v_mfma_f32_32x32x16_bf16 v[48:63], v[132:135], v[108:111], v[48:63]
    buffer_load_dwordx4 v[108:111], v7, s[20:23], s10 offen offset:2048 sc1
    s_setprio 3
L_gated__mbw_38:
    ds_read_b32 v136, v8 offset:68
    s_waitcnt lgkmcnt(0)
    v_readfirstlane_b32 s4, v136
    s_cmp_ge_u32 s4, s34
    s_cbranch_scc1 L_gated__mbw_38d
    s_sleep 1
    s_branch L_gated__mbw_38
L_gated__mbw_38d:
    s_setprio 0
    ds_read_b64_tr_b16 v[112:113], v6 offset:0
    ds_read_b64_tr_b16 v[114:115], v6 offset:768
    ds_read_b64_tr_b16 v[116:117], v6 offset:64
    ds_read_b64_tr_b16 v[118:119], v6 offset:832
    ds_read_b64_tr_b16 v[120:121], v6 offset:128
    ds_read_b64_tr_b16 v[122:123], v6 offset:896
    s_xor_b32 s11, s32, 3
    s_mul_i32 s11, s11, 176128
    s_add_u32 s11, s11, s29
    s_add_u32 m0, s7, 12288
    s_nop 0
    buffer_load_dwordx4 v3, s[12:15], s11 offen lds
    s_add_u32 m0, s7, 13312
    s_nop 0
    buffer_load_dwordx4 v4, s[12:15], s11 offen lds
    s_add_u32 m0, s7, 14336
    s_nop 0
    buffer_load_dwordx4 v5, s[12:15], s11 offen lds
    s_xor_b32 s10, s32, 4
    s_lshl_b32 s10, s10, 13
    s_add_u32 s10, s10, s28
    s_waitcnt lgkmcnt(4)
    v_mfma_f32_32x32x16_bf16 v[16:31], v[112:115], v[80:83], v[16:31]
    ds_read_b64_tr_b16 v[124:125], v6 offset:3072
    ds_read_b64_tr_b16 v[126:127], v6 offset:3840
    s_waitcnt lgkmcnt(4)
    v_mfma_f32_32x32x16_bf16 v[32:47], v[116:119], v[80:83], v[32:47]
    ds_read_b64_tr_b16 v[128:129], v6 offset:3136
    ds_read_b64_tr_b16 v[130:131], v6 offset:3904
    s_waitcnt lgkmcnt(4)
    v_mfma_f32_32x32x16_bf16 v[48:63], v[120:123], v[80:83], v[48:63]
    ds_read_b64_tr_b16 v[132:133], v6 offset:3200
    ds_read_b64_tr_b16 v[134:135], v6 offset:3968
    buffer_load_dwordx4 v[80:83], v14, s[20:23], s10 offen offset:0 sc1
    s_waitcnt lgkmcnt(4)
    v_mfma_f32_32x32x16_bf16 v[16:31], v[124:127], v[84:87], v[16:31]
    ds_read_b64_tr_b16 v[112:113], v6 offset:6144
    ds_read_b64_tr_b16 v[114:115], v6 offset:6912
    s_waitcnt lgkmcnt(4)
    v_mfma_f32_32x32x16_bf16 v[32:47], v[128:131], v[84:87], v[32:47]
    ds_read_b64_tr_b16 v[116:117], v6 offset:6208
    ds_read_b64_tr_b16 v[118:119], v6 offset:6976
    s_waitcnt lgkmcnt(4)
    v_mfma_f32_32x32x16_bf16 v[48:63], v[132:135], v[84:87], v[48:63]
    ds_read_b64_tr_b16 v[120:121], v6 offset:6272
    ds_read_b64_tr_b16 v[122:123], v6 offset:7040
    buffer_load_dwordx4 v[84:87], v14, s[20:23], s10 offen offset:2048 sc1
    s_waitcnt lgkmcnt(4)
    v_mfma_f32_32x32x16_bf16 v[16:31], v[112:115], v[88:91], v[16:31]
    ds_read_b64_tr_b16 v[124:125], v6 offset:9216
    ds_read_b64_tr_b16 v[126:127], v6 offset:9984
    s_waitcnt lgkmcnt(4)
    v_mfma_f32_32x32x16_bf16 v[32:47], v[116:119], v[88:91], v[32:47]
    ds_read_b64_tr_b16 v[128:129], v6 offset:9280
    ds_read_b64_tr_b16 v[130:131], v6 offset:10048
    s_waitcnt lgkmcnt(4)
    v_mfma_f32_32x32x16_bf16 v[48:63], v[120:123], v[88:91], v[48:63]
    ds_read_b64_tr_b16 v[132:133], v6 offset:9344
    ds_read_b64_tr_b16 v[134:135], v6 offset:10112
    buffer_load_dwordx4 v[88:91], v7, s[20:23], s10 offen offset:0 sc1
    s_waitcnt vmcnt(3) lgkmcnt(0)
    s_mov_b64 exec, 1
    ds_add_u32 v8, v9 offset:68
    s_mov_b64 exec, -1
    s_add_u32 s34, s34, 4
    v_mfma_f32_32x32x16_bf16 v[16:31], v[124:127], v[92:95], v[16:31]
    v_mfma_f32_32x32x16_bf16 v[32:47], v[128:131], v[92:95], v[32:47]
    v_mfma_f32_32x32x16_bf16 v[48:63], v[132:135], v[92:95], v[48:63]
    buffer_load_dwordx4 v[92:95], v7, s[20:23], s10 offen offset:2048 sc1
    s_setprio 3
L_gated__mbw_39:
    ds_read_b32 v136, v8 offset:68
    s_waitcnt lgkmcnt(0)
    v_readfirstlane_b32 s4, v136
    s_cmp_ge_u32 s4, s34
    s_cbranch_scc1 L_gated__mbw_39d
    s_sleep 1
    s_branch L_gated__mbw_39
L_gated__mbw_39d:
    s_setprio 0
    ds_read_b64_tr_b16 v[112:113], v6 offset:12288
    ds_read_b64_tr_b16 v[114:115], v6 offset:13056
    ds_read_b64_tr_b16 v[116:117], v6 offset:12352
    ds_read_b64_tr_b16 v[118:119], v6 offset:13120
    ds_read_b64_tr_b16 v[120:121], v6 offset:12416
    ds_read_b64_tr_b16 v[122:123], v6 offset:13184
    s_xor_b32 s11, s32, 4
    s_mul_i32 s11, s11, 176128
    s_add_u32 s11, s11, s29
    s_add_u32 m0, s7, 0
    s_nop 0
    buffer_load_dwordx4 v3, s[12:15], s11 offen lds
    s_add_u32 m0, s7, 1024
    s_nop 0
    buffer_load_dwordx4 v4, s[12:15], s11 offen lds
    s_add_u32 m0, s7, 2048
    s_nop 0
    buffer_load_dwordx4 v5, s[12:15], s11 offen lds
    s_xor_b32 s10, s32, 5
    s_lshl_b32 s10, s10, 13
    s_add_u32 s10, s10, s28
    s_waitcnt lgkmcnt(4)
    v_mfma_f32_32x32x16_bf16 v[16:31], v[112:115], v[96:99], v[16:31]
    ds_read_b64_tr_b16 v[124:125], v6 offset:15360
    ds_read_b64_tr_b16 v[126:127], v6 offset:16128
    s_waitcnt lgkmcnt(4)
    v_mfma_f32_32x32x16_bf16 v[32:47], v[116:119], v[96:99], v[32:47]
    ds_read_b64_tr_b16 v[128:129], v6 offset:15424
    ds_read_b64_tr_b16 v[130:131], v6 offset:16192
    s_waitcnt lgkmcnt(4)
    v_mfma_f32_32x32x16_bf16 v[48:63], v[120:123], v[96:99], v[48:63]
    ds_read_b64_tr_b16 v[132:133], v6 offset:15488
    ds_read_b64_tr_b16 v[134:135], v6 offset:16256
    buffer_load_dwordx4 v[96:99], v14, s[20:23], s10 offen offset:0 sc1
    s_waitcnt lgkmcnt(4)
    v_mfma_f32_32x32x16_bf16 v[16:31], v[124:127], v[100:103], v[16:31]
    ds_read_b64_tr_b16 v[112:113], v6 offset:18432
    ds_read_b64_tr_b16 v[114:115], v6 offset:19200
    s_waitcnt lgkmcnt(4)
    v_mfma_f32_32x32x16_bf16 v[32:47], v[128:131], v[100:103], v[32:47]
    ds_read_b64_tr_b16 v[116:117], v6 offset:18496
    ds_read_b64_tr_b16 v[118:119], v6 offset:19264
    s_waitcnt lgkmcnt(4)
    v_mfma_f32_32x32x16_bf16 v[48:63], v[132:135], v[100:103], v[48:63]
    ds_read_b64_tr_b16 v[120:121], v6 offset:18560
    ds_read_b64_tr_b16 v[122:123], v6 offset:19328
    buffer_load_dwordx4 v[100:103], v14, s[20:23], s10 offen offset:2048 sc1
    s_waitcnt lgkmcnt(4)
    v_mfma_f32_32x32x16_bf16 v[16:31], v[112:115], v[104:107], v[16:31]
    ds_read_b64_tr_b16 v[124:125], v6 offset:21504
    ds_read_b64_tr_b16 v[126:127], v6 offset:22272
    s_waitcnt lgkmcnt(4)
    v_mfma_f32_32x32x16_bf16 v[32:47], v[116:119], v[104:107], v[32:47]
    ds_read_b64_tr_b16 v[128:129], v6 offset:21568
    ds_read_b64_tr_b16 v[130:131], v6 offset:22336
    s_waitcnt lgkmcnt(4)
    v_mfma_f32_32x32x16_bf16 v[48:63], v[120:123], v[104:107], v[48:63]
    ds_read_b64_tr_b16 v[132:133], v6 offset:21632
    ds_read_b64_tr_b16 v[134:135], v6 offset:22400
    buffer_load_dwordx4 v[104:107], v7, s[20:23], s10 offen offset:0 sc1
    s_waitcnt vmcnt(3) lgkmcnt(0)
    s_mov_b64 exec, 1
    ds_add_u32 v8, v9 offset:68
    s_mov_b64 exec, -1
    s_add_u32 s34, s34, 4
    v_mfma_f32_32x32x16_bf16 v[16:31], v[124:127], v[108:111], v[16:31]
    v_mfma_f32_32x32x16_bf16 v[32:47], v[128:131], v[108:111], v[32:47]
    v_mfma_f32_32x32x16_bf16 v[48:63], v[132:135], v[108:111], v[48:63]
    buffer_load_dwordx4 v[108:111], v7, s[20:23], s10 offen offset:2048 sc1
    s_setprio 3
L_gated__mbw_40:
    ds_read_b32 v136, v8 offset:68
    s_waitcnt lgkmcnt(0)
    v_readfirstlane_b32 s4, v136
    s_cmp_ge_u32 s4, s34
    s_cbranch_scc1 L_gated__mbw_40d
    s_sleep 1
    s_branch L_gated__mbw_40
L_gated__mbw_40d:
    s_setprio 0
    ds_read_b64_tr_b16 v[112:113], v6 offset:0
    ds_read_b64_tr_b16 v[114:115], v6 offset:768
    ds_read_b64_tr_b16 v[116:117], v6 offset:64
    ds_read_b64_tr_b16 v[118:119], v6 offset:832
    ds_read_b64_tr_b16 v[120:121], v6 offset:128
    ds_read_b64_tr_b16 v[122:123], v6 offset:896
    s_xor_b32 s11, s32, 5
    s_mul_i32 s11, s11, 176128
    s_add_u32 s11, s11, s29
    s_add_u32 m0, s7, 12288
    s_nop 0
    buffer_load_dwordx4 v3, s[12:15], s11 offen lds
    s_add_u32 m0, s7, 13312
    s_nop 0
    buffer_load_dwordx4 v4, s[12:15], s11 offen lds
    s_add_u32 m0, s7, 14336
    s_nop 0
    buffer_load_dwordx4 v5, s[12:15], s11 offen lds
    s_xor_b32 s10, s32, 6
    s_lshl_b32 s10, s10, 13
    s_add_u32 s10, s10, s28
    s_waitcnt lgkmcnt(4)
    v_mfma_f32_32x32x16_bf16 v[16:31], v[112:115], v[80:83], v[16:31]
    ds_read_b64_tr_b16 v[124:125], v6 offset:3072
    ds_read_b64_tr_b16 v[126:127], v6 offset:3840
    s_waitcnt lgkmcnt(4)
    v_mfma_f32_32x32x16_bf16 v[32:47], v[116:119], v[80:83], v[32:47]
    ds_read_b64_tr_b16 v[128:129], v6 offset:3136
    ds_read_b64_tr_b16 v[130:131], v6 offset:3904
    s_waitcnt lgkmcnt(4)
    v_mfma_f32_32x32x16_bf16 v[48:63], v[120:123], v[80:83], v[48:63]
    ds_read_b64_tr_b16 v[132:133], v6 offset:3200
    ds_read_b64_tr_b16 v[134:135], v6 offset:3968
    buffer_load_dwordx4 v[80:83], v14, s[20:23], s10 offen offset:0 sc1
    s_waitcnt lgkmcnt(4)
    v_mfma_f32_32x32x16_bf16 v[16:31], v[124:127], v[84:87], v[16:31]
    ds_read_b64_tr_b16 v[112:113], v6 offset:6144
    ds_read_b64_tr_b16 v[114:115], v6 offset:6912
    s_waitcnt lgkmcnt(4)
    v_mfma_f32_32x32x16_bf16 v[32:47], v[128:131], v[84:87], v[32:47]
    ds_read_b64_tr_b16 v[116:117], v6 offset:6208
    ds_read_b64_tr_b16 v[118:119], v6 offset:6976
    s_waitcnt lgkmcnt(4)
    v_mfma_f32_32x32x16_bf16 v[48:63], v[132:135], v[84:87], v[48:63]
    ds_read_b64_tr_b16 v[120:121], v6 offset:6272
    ds_read_b64_tr_b16 v[122:123], v6 offset:7040
    buffer_load_dwordx4 v[84:87], v14, s[20:23], s10 offen offset:2048 sc1
    s_waitcnt lgkmcnt(4)
    v_mfma_f32_32x32x16_bf16 v[16:31], v[112:115], v[88:91], v[16:31]
    ds_read_b64_tr_b16 v[124:125], v6 offset:9216
    ds_read_b64_tr_b16 v[126:127], v6 offset:9984
    s_waitcnt lgkmcnt(4)
    v_mfma_f32_32x32x16_bf16 v[32:47], v[116:119], v[88:91], v[32:47]
    ds_read_b64_tr_b16 v[128:129], v6 offset:9280
    ds_read_b64_tr_b16 v[130:131], v6 offset:10048
    s_waitcnt lgkmcnt(4)
    v_mfma_f32_32x32x16_bf16 v[48:63], v[120:123], v[88:91], v[48:63]
    ds_read_b64_tr_b16 v[132:133], v6 offset:9344
    ds_read_b64_tr_b16 v[134:135], v6 offset:10112
    buffer_load_dwordx4 v[88:91], v7, s[20:23], s10 offen offset:0 sc1
    s_waitcnt vmcnt(3) lgkmcnt(0)
    s_mov_b64 exec, 1
    ds_add_u32 v8, v9 offset:68
    s_mov_b64 exec, -1
    s_add_u32 s34, s34, 4
    v_mfma_f32_32x32x16_bf16 v[16:31], v[124:127], v[92:95], v[16:31]
    v_mfma_f32_32x32x16_bf16 v[32:47], v[128:131], v[92:95], v[32:47]
    v_mfma_f32_32x32x16_bf16 v[48:63], v[132:135], v[92:95], v[48:63]
    buffer_load_dwordx4 v[92:95], v7, s[20:23], s10 offen offset:2048 sc1
    s_setprio 3
L_gated__mbw_41:
    ds_read_b32 v136, v8 offset:68
    s_waitcnt lgkmcnt(0)
    v_readfirstlane_b32 s4, v136
    s_cmp_ge_u32 s4, s34
    s_cbranch_scc1 L_gated__mbw_41d
    s_sleep 1
    s_branch L_gated__mbw_41
L_gated__mbw_41d:
    s_setprio 0
    ds_read_b64_tr_b16 v[112:113], v6 offset:12288
    ds_read_b64_tr_b16 v[114:115], v6 offset:13056
    ds_read_b64_tr_b16 v[116:117], v6 offset:12352
    ds_read_b64_tr_b16 v[118:119], v6 offset:13120
    ds_read_b64_tr_b16 v[120:121], v6 offset:12416
    ds_read_b64_tr_b16 v[122:123], v6 offset:13184
    s_xor_b32 s11, s32, 6
    s_mul_i32 s11, s11, 176128
    s_add_u32 s11, s11, s29
    s_add_u32 m0, s7, 0
    s_nop 0
    buffer_load_dwordx4 v3, s[12:15], s11 offen lds
    s_add_u32 m0, s7, 1024
    s_nop 0
    buffer_load_dwordx4 v4, s[12:15], s11 offen lds
    s_add_u32 m0, s7, 2048
    s_nop 0
    buffer_load_dwordx4 v5, s[12:15], s11 offen lds
    s_xor_b32 s10, s32, 7
    s_lshl_b32 s10, s10, 13
    s_add_u32 s10, s10, s28
    s_waitcnt lgkmcnt(4)
    v_mfma_f32_32x32x16_bf16 v[16:31], v[112:115], v[96:99], v[16:31]
    ds_read_b64_tr_b16 v[124:125], v6 offset:15360
    ds_read_b64_tr_b16 v[126:127], v6 offset:16128
    s_waitcnt lgkmcnt(4)
    v_mfma_f32_32x32x16_bf16 v[32:47], v[116:119], v[96:99], v[32:47]
    ds_read_b64_tr_b16 v[128:129], v6 offset:15424
    ds_read_b64_tr_b16 v[130:131], v6 offset:16192
    s_waitcnt lgkmcnt(4)
    v_mfma_f32_32x32x16_bf16 v[48:63], v[120:123], v[96:99], v[48:63]
    ds_read_b64_tr_b16 v[132:133], v6 offset:15488
    ds_read_b64_tr_b16 v[134:135], v6 offset:16256
    buffer_load_dwordx4 v[96:99], v14, s[20:23], s10 offen offset:0 sc1
    s_waitcnt lgkmcnt(4)
    v_mfma_f32_32x32x16_bf16 v[16:31], v[124:127], v[100:103], v[16:31]
    ds_read_b64_tr_b16 v[112:113], v6 offset:18432
    ds_read_b64_tr_b16 v[114:115], v6 offset:19200
    s_waitcnt lgkmcnt(4)
    v_mfma_f32_32x32x16_bf16 v[32:47], v[128:131], v[100:103], v[32:47]
    ds_read_b64_tr_b16 v[116:117], v6 offset:18496
    ds_read_b64_tr_b16 v[118:119], v6 offset:19264
    s_waitcnt lgkmcnt(4)
    v_mfma_f32_32x32x16_bf16 v[48:63], v[132:135], v[100:103], v[48:63]
    ds_read_b64_tr_b16 v[120:121], v6 offset:18560
    ds_read_b64_tr_b16 v[122:123], v6 offset:19328
    buffer_load_dwordx4 v[100:103], v14, s[20:23], s10 offen offset:2048 sc1
    s_waitcnt lgkmcnt(4)
    v_mfma_f32_32x32x16_bf16 v[16:31], v[112:115], v[104:107], v[16:31]
    ds_read_b64_tr_b16 v[124:125], v6 offset:21504
    ds_read_b64_tr_b16 v[126:127], v6 offset:22272
    s_waitcnt lgkmcnt(4)
    v_mfma_f32_32x32x16_bf16 v[32:47], v[116:119], v[104:107], v[32:47]
    ds_read_b64_tr_b16 v[128:129], v6 offset:21568
    ds_read_b64_tr_b16 v[130:131], v6 offset:22336
    s_waitcnt lgkmcnt(4)
    v_mfma_f32_32x32x16_bf16 v[48:63], v[120:123], v[104:107], v[48:63]
    ds_read_b64_tr_b16 v[132:133], v6 offset:21632
    ds_read_b64_tr_b16 v[134:135], v6 offset:22400
    buffer_load_dwordx4 v[104:107], v7, s[20:23], s10 offen offset:0 sc1
    s_waitcnt vmcnt(3) lgkmcnt(0)
    s_mov_b64 exec, 1
    ds_add_u32 v8, v9 offset:68
    s_mov_b64 exec, -1
    s_add_u32 s34, s34, 4
    v_mfma_f32_32x32x16_bf16 v[16:31], v[124:127], v[108:111], v[16:31]
    v_mfma_f32_32x32x16_bf16 v[32:47], v[128:131], v[108:111], v[32:47]
    v_mfma_f32_32x32x16_bf16 v[48:63], v[132:135], v[108:111], v[48:63]
    buffer_load_dwordx4 v[108:111], v7, s[20:23], s10 offen offset:2048 sc1
    s_setprio 3
L_gated__mbw_42:
    ds_read_b32 v136, v8 offset:68
    s_waitcnt lgkmcnt(0)
    v_readfirstlane_b32 s4, v136
    s_cmp_ge_u32 s4, s34
    s_cbranch_scc1 L_gated__mbw_42d
    s_sleep 1
    s_branch L_gated__mbw_42
L_gated__mbw_42d:
    s_setprio 0
    ds_read_b64_tr_b16 v[112:113], v6 offset:0
    ds_read_b64_tr_b16 v[114:115], v6 offset:768
    ds_read_b64_tr_b16 v[116:117], v6 offset:64
    ds_read_b64_tr_b16 v[118:119], v6 offset:832
    ds_read_b64_tr_b16 v[120:121], v6 offset:128
    ds_read_b64_tr_b16 v[122:123], v6 offset:896
    s_xor_b32 s11, s32, 7
    s_mul_i32 s11, s11, 176128
    s_add_u32 s11, s11, s29
    s_add_u32 m0, s7, 12288
    s_nop 0
    buffer_load_dwordx4 v3, s[12:15], s11 offen lds
    s_add_u32 m0, s7, 13312
    s_nop 0
    buffer_load_dwordx4 v4, s[12:15], s11 offen lds
    s_add_u32 m0, s7, 14336
    s_nop 0
    buffer_load_dwordx4 v5, s[12:15], s11 offen lds
    s_waitcnt lgkmcnt(4)
    v_mfma_f32_32x32x16_bf16 v[16:31], v[112:115], v[80:83], v[16:31]
    ds_read_b64_tr_b16 v[124:125], v6 offset:3072
    ds_read_b64_tr_b16 v[126:127], v6 offset:3840
    s_waitcnt lgkmcnt(4)
    v_mfma_f32_32x32x16_bf16 v[32:47], v[116:119], v[80:83], v[32:47]
    ds_read_b64_tr_b16 v[128:129], v6 offset:3136
    ds_read_b64_tr_b16 v[130:131], v6 offset:3904
    s_waitcnt lgkmcnt(4)
    v_mfma_f32_32x32x16_bf16 v[48:63], v[120:123], v[80:83], v[48:63]
    ds_read_b64_tr_b16 v[132:133], v6 offset:3200
    ds_read_b64_tr_b16 v[134:135], v6 offset:3968
    s_waitcnt lgkmcnt(4)
    v_mfma_f32_32x32x16_bf16 v[16:31], v[124:127], v[84:87], v[16:31]
    ds_read_b64_tr_b16 v[112:113], v6 offset:6144
    ds_read_b64_tr_b16 v[114:115], v6 offset:6912
    s_waitcnt lgkmcnt(4)
    v_mfma_f32_32x32x16_bf16 v[32:47], v[128:131], v[84:87], v[32:47]
    ds_read_b64_tr_b16 v[116:117], v6 offset:6208
    ds_read_b64_tr_b16 v[118:119], v6 offset:6976
    s_waitcnt lgkmcnt(4)
    v_mfma_f32_32x32x16_bf16 v[48:63], v[132:135], v[84:87], v[48:63]
    ds_read_b64_tr_b16 v[120:121], v6 offset:6272
    ds_read_b64_tr_b16 v[122:123], v6 offset:7040
    s_waitcnt lgkmcnt(4)
    v_mfma_f32_32x32x16_bf16 v[16:31], v[112:115], v[88:91], v[16:31]
    ds_read_b64_tr_b16 v[124:125], v6 offset:9216
    ds_read_b64_tr_b16 v[126:127], v6 offset:9984
    s_waitcnt lgkmcnt(4)
    v_mfma_f32_32x32x16_bf16 v[32:47], v[116:119], v[88:91], v[32:47]
    ds_read_b64_tr_b16 v[128:129], v6 offset:9280
    ds_read_b64_tr_b16 v[130:131], v6 offset:10048
    s_waitcnt lgkmcnt(4)
    v_mfma_f32_32x32x16_bf16 v[48:63], v[120:123], v[88:91], v[48:63]
    ds_read_b64_tr_b16 v[132:133], v6 offset:9344
    ds_read_b64_tr_b16 v[134:135], v6 offset:10112
    s_waitcnt vmcnt(0) lgkmcnt(0)
    s_mov_b64 exec, 1
    ds_add_u32 v8, v9 offset:68
    s_mov_b64 exec, -1
    s_add_u32 s34, s34, 4
    v_mfma_f32_32x32x16_bf16 v[16:31], v[124:127], v[92:95], v[16:31]
    v_mfma_f32_32x32x16_bf16 v[32:47], v[128:131], v[92:95], v[32:47]
    v_mfma_f32_32x32x16_bf16 v[48:63], v[132:135], v[92:95], v[48:63]
    s_setprio 3
L_gated__mbw_43:
    ds_read_b32 v136, v8 offset:68
    s_waitcnt lgkmcnt(0)
    v_readfirstlane_b32 s4, v136
    s_cmp_ge_u32 s4, s34
    s_cbranch_scc1 L_gated__mbw_43d
    s_sleep 1
    s_branch L_gated__mbw_43
L_gated__mbw_43d:
    s_setprio 0
    ds_read_b64_tr_b16 v[112:113], v6 offset:12288
    ds_read_b64_tr_b16 v[114:115], v6 offset:13056
    ds_read_b64_tr_b16 v[116:117], v6 offset:12352
    ds_read_b64_tr_b16 v[118:119], v6 offset:13120
    ds_read_b64_tr_b16 v[120:121], v6 offset:12416
    ds_read_b64_tr_b16 v[122:123], v6 offset:13184
    s_waitcnt lgkmcnt(4)
    v_mfma_f32_32x32x16_bf16 v[16:31], v[112:115], v[96:99], v[16:31]
    ds_read_b64_tr_b16 v[124:125], v6 offset:15360
    ds_read_b64_tr_b16 v[126:127], v6 offset:16128
    s_waitcnt lgkmcnt(4)
    v_mfma_f32_32x32x16_bf16 v[32:47], v[116:119], v[96:99], v[32:47]
    ds_read_b64_tr_b16 v[128:129], v6 offset:15424
    ds_read_b64_tr_b16 v[130:131], v6 offset:16192
    s_waitcnt lgkmcnt(4)
    v_mfma_f32_32x32x16_bf16 v[48:63], v[120:123], v[96:99], v[48:63]
    ds_read_b64_tr_b16 v[132:133], v6 offset:15488
    ds_read_b64_tr_b16 v[134:135], v6 offset:16256
    s_waitcnt lgkmcnt(4)
    v_mfma_f32_32x32x16_bf16 v[16:31], v[124:127], v[100:103], v[16:31]
    ds_read_b64_tr_b16 v[112:113], v6 offset:18432
    ds_read_b64_tr_b16 v[114:115], v6 offset:19200
    s_waitcnt lgkmcnt(4)
    v_mfma_f32_32x32x16_bf16 v[32:47], v[128:131], v[100:103], v[32:47]
    ds_read_b64_tr_b16 v[116:117], v6 offset:18496
    ds_read_b64_tr_b16 v[118:119], v6 offset:19264
    s_waitcnt lgkmcnt(4)
    v_mfma_f32_32x32x16_bf16 v[48:63], v[132:135], v[100:103], v[48:63]
    ds_read_b64_tr_b16 v[120:121], v6 offset:18560
    ds_read_b64_tr_b16 v[122:123], v6 offset:19328
    s_waitcnt lgkmcnt(4)
    v_mfma_f32_32x32x16_bf16 v[16:31], v[112:115], v[104:107], v[16:31]
    ds_read_b64_tr_b16 v[124:125], v6 offset:21504
    ds_read_b64_tr_b16 v[126:127], v6 offset:22272
    s_waitcnt lgkmcnt(4)
    v_mfma_f32_32x32x16_bf16 v[32:47], v[116:119], v[104:107], v[32:47]
    ds_read_b64_tr_b16 v[128:129], v6 offset:21568
    ds_read_b64_tr_b16 v[130:131], v6 offset:22336
    s_waitcnt lgkmcnt(4)
    v_mfma_f32_32x32x16_bf16 v[48:63], v[120:123], v[104:107], v[48:63]
    ds_read_b64_tr_b16 v[132:133], v6 offset:21632
    ds_read_b64_tr_b16 v[134:135], v6 offset:22400
    s_waitcnt lgkmcnt(4)
    v_mfma_f32_32x32x16_bf16 v[16:31], v[124:127], v[108:111], v[16:31]
    s_waitcnt lgkmcnt(2)
    v_mfma_f32_32x32x16_bf16 v[32:47], v[128:131], v[108:111], v[32:47]
    s_waitcnt lgkmcnt(0)
    v_mfma_f32_32x32x16_bf16 v[48:63], v[132:135], v[108:111], v[48:63]
    s_setprio 3
    s_mul_i32 s10, s27, 15
    s_add_u32 s10, s10, s26
    s_lshl_b32 s10, s10, 2
    s_add_u32 s10, s10, s33
    s_mul_i32 s10, s10, 24576
    s_lshl_b32 s11, s6, 11
    s_add_u32 s10, s10, s11
    s_add_u32 s10, s10, 16777216
    s_lshl_b32 s11, s27, 4
    s_add_u32 s11, s11, s26
    s_lshl_b32 s11, s11, 2
    s_add_u32 s11, s11, s33
    s_lshl_b32 s11, s11, 2
    s_add_u32 s11, s11, s6
    s_lshl_b32 s11, s11, 7
    s_add_u32 s11, s11, 13369344
    v_cvt_pk_bf16_f32 v80, v16, v17
    v_cvt_pk_bf16_f32 v81, v18, v19
    v_cvt_pk_bf16_f32 v82, v20, v21
    v_cvt_pk_bf16_f32 v83, v22, v23
    v_cvt_pk_bf16_f32 v84, v24, v25
    v_cvt_pk_bf16_f32 v85, v26, v27
    v_cvt_pk_bf16_f32 v86, v28, v29
    v_cvt_pk_bf16_f32 v87, v30, v31
    s_add_u32 s4, s10, 0
    buffer_store_dwordx4 v[80:83], v14, s[20:23], s4 offen sc1
    buffer_store_dwordx4 v[84:87], v14, s[20:23], s4 offen offset:1024 sc1
    v_cvt_pk_bf16_f32 v88, v32, v33
    v_cvt_pk_bf16_f32 v89, v34, v35
    v_cvt_pk_bf16_f32 v90, v36, v37
    v_cvt_pk_bf16_f32 v91, v38, v39
    v_cvt_pk_bf16_f32 v92, v40, v41
    v_cvt_pk_bf16_f32 v93, v42, v43
    v_cvt_pk_bf16_f32 v94, v44, v45
    v_cvt_pk_bf16_f32 v95, v46, v47
    s_add_u32 s4, s10, 8192
    buffer_store_dwordx4 v[88:91], v14, s[20:23], s4 offen sc1
    buffer_store_dwordx4 v[92:95], v14, s[20:23], s4 offen offset:1024 sc1
    v_cvt_pk_bf16_f32 v96, v48, v49
    v_cvt_pk_bf16_f32 v97, v50, v51
    v_cvt_pk_bf16_f32 v98, v52, v53
    v_cvt_pk_bf16_f32 v99, v54, v55
    v_cvt_pk_bf16_f32 v100, v56, v57
    v_cvt_pk_bf16_f32 v101, v58, v59
    v_cvt_pk_bf16_f32 v102, v60, v61
    v_cvt_pk_bf16_f32 v103, v62, v63
    s_add_u32 s4, s10, 16384
    buffer_store_dwordx4 v[96:99], v14, s[20:23], s4 offen sc1
    buffer_store_dwordx4 v[100:103], v14, s[20:23], s4 offen offset:1024 sc1
    v_lshlrev_b32 v128, 2, v2
    v_mov_b32 v129, s35
    s_waitcnt vmcnt(0)
    s_mov_b32 exec_hi, 0
    buffer_store_dword v129, v128, s[20:23], s11 offen sc1
    s_mov_b64 exec, -1
    s_waitcnt lgkmcnt(0)
    s_mov_b64 exec, 1
    ds_add_u32 v8, v9 offset:68
    s_mov_b64 exec, -1
    s_add_u32 s34, s34, 4
L_gated__mbar_44:
    ds_read_b32 v128, v8 offset:68
    s_waitcnt lgkmcnt(0)
    v_readfirstlane_b32 s4, v128
    s_cmp_ge_u32 s4, s34
    s_cbranch_scc1 L_gated__mbar_44d
    s_sleep 1
    s_branch L_gated__mbar_44
L_gated__mbar_44d:
L_m_g1done:
    s_mov_b32 s12, s40
    s_and_b32 s13, s41, 0xffff
    s_mov_b32 s14, 0x80000
    s_mov_b32 s15, 0x00020000
    s_cmp_lg_u32 s33, 3
    s_cbranch_scc1 L_m_red
    v_lshlrev_b32 v130, 7, v2
    s_lshl_b32 s10, s25, 14
    s_add_u32 s11, s10, 8192
    buffer_load_dword v132, v130, s[12:15], s10 offen
    buffer_load_dword v132, v130, s[12:15], s11 offen
    s_branch L_m_g2
L_m_red:
    s_and_b32 s26, s24, 1
    s_mul_i32 s26, s26, 30
    s_add_u32 s26, s26, s25
    s_and_b32 s27, s26, 3
    s_lshr_b32 s26, s26, 2
    s_lshr_b32 s28, s24, 1
    s_cmp_ge_u32 s25, 30
    s_cbranch_scc1 L_m_skipred
    s_mul_i32 s29, s26, 3
    s_add_u32 s29, s29, s33
    s_cmp_ge_u32 s29, 44
    s_cbranch_scc1 L_m_skipred
    s_lshl_b32 s10, s27, 4
    s_add_u32 s10, s10, s26
    s_lshl_b32 s10, s10, 2
    s_add_u32 s10, s10, s28
    s_lshl_b32 s10, s10, 9
    s_add_u32 s10, s10, 13369344
    v_and_b32 v15, 3, v2
    v_lshlrev_b32 v15, 7, v15
    s_lshl_b32 s11, s29, 6
    v_lshrrev_b32 v129, 5, v2
    v_lshlrev_b32 v129, 3, v129
    buffer_load_dwordx2 v[112:113], v129, s[16:19], s11 offen offset:0
    buffer_load_dwordx2 v[114:115], v129, s[16:19], s11 offen offset:16
    buffer_load_dwordx2 v[116:117], v129, s[16:19], s11 offen offset:32
    buffer_load_dwordx2 v[118:119], v129, s[16:19], s11 offen offset:48
    s_mov_b32 s5, 0
L_gated__fp_45:
    buffer_load_dword v128, v15, s[20:23], s10 offen sc1
    s_add_u32 s5, s5, 1
    s_waitcnt vmcnt(0)
    v_cmp_ne_u32 vcc, s35, v128
    s_and_b64 exec, exec, vcc
    s_cbranch_scc0 L_gated__fpd_46
    s_sleep 2
    s_cmp_lt_u32 s5, 262144
    s_cbranch_scc1 L_gated__fp_45
L_gated__fpd_46:
    s_mov_b64 exec, -1
    s_mul_i32 s10, s27, 15
    s_add_u32 s10, s10, s26
    s_lshl_b32 s10, s10, 2
    s_add_u32 s10, s10, s28
    s_mul_i32 s10, s10, 3
    s_add_u32 s10, s10, s33
    s_lshl_b32 s10, s10, 13
    s_add_u32 s10, s10, 16777216
    s_add_u32 s11, s10, 4096
    buffer_load_dwordx4 v[80:83], v14, s[20:23], s10 offen offset:0 sc1
    buffer_load_dwordx4 v[84:87], v14, s[20:23], s10 offen offset:1024 sc1
    buffer_load_dwordx4 v[88:91], v14, s[20:23], s10 offen offset:2048 sc1
    buffer_load_dwordx4 v[92:95], v14, s[20:23], s10 offen offset:3072 sc1
    buffer_load_dwordx4 v[96:99], v14, s[20:23], s11 offen offset:0 sc1
    buffer_load_dwordx4 v[100:103], v14, s[20:23], s11 offen offset:1024 sc1
    buffer_load_dwordx4 v[104:107], v14, s[20:23], s11 offen offset:2048 sc1
    buffer_load_dwordx4 v[108:111], v14, s[20:23], s11 offen offset:3072 sc1
    s_mov_b32 s6, 0x00003f80
    s_mov_b32 s7, 0x3f800000
    s_mov_b32 s10, 0xbdd2d3e8
    s_mov_b32 s11, s10
    v_mov_b32 v32, 0xc0135761
    v_mov_b32 v33, 0xc0135761
    v_lshlrev_b32 v16, 16, v112
    v_and_b32 v17, 0xffff0000, v112
    v_lshlrev_b32 v18, 16, v113
    v_and_b32 v19, 0xffff0000, v113
    v_lshlrev_b32 v20, 16, v114
    v_and_b32 v21, 0xffff0000, v114
    v_lshlrev_b32 v22, 16, v115
    v_and_b32 v23, 0xffff0000, v115
    v_lshlrev_b32 v24, 16, v116
    v_and_b32 v25, 0xffff0000, v116
    v_lshlrev_b32 v26, 16, v117
    v_and_b32 v27, 0xffff0000, v117
    v_lshlrev_b32 v28, 16, v118
    v_and_b32 v29, 0xffff0000, v118
    v_lshlrev_b32 v30, 16, v119
    v_and_b32 v31, 0xffff0000, v119
    s_waitcnt vmcnt(6)
    v_dot2_f32_bf16 v16, v80, s6, v16
    v_dot2_f32_bf16 v17, v80, s7, v17
    v_dot2_f32_bf16 v18, v81, s6, v18
    v_dot2_f32_bf16 v19, v81, s7, v19
    v_dot2_f32_bf16 v20, v82, s6, v20
    v_dot2_f32_bf16 v21, v82, s7, v21
    v_dot2_f32_bf16 v22, v83, s6, v22
    v_dot2_f32_bf16 v23, v83, s7, v23
    v_dot2_f32_bf16 v24, v84, s6, v24
    v_dot2_f32_bf16 v25, v84, s7, v25
    v_dot2_f32_bf16 v26, v85, s6, v26
    v_dot2_f32_bf16 v27, v85, s7, v27
    v_dot2_f32_bf16 v28, v86, s6, v28
    v_dot2_f32_bf16 v29, v86, s7, v29
    v_dot2_f32_bf16 v30, v87, s6, v30
    v_dot2_f32_bf16 v31, v87, s7, v31
    s_waitcnt vmcnt(4)
    v_dot2_f32_bf16 v16, v88, s6, v16
    v_dot2_f32_bf16 v17, v88, s7, v17
    v_dot2_f32_bf16 v18, v89, s6, v18
    v_dot2_f32_bf16 v19, v89, s7, v19
    v_dot2_f32_bf16 v20, v90, s6, v20
    v_dot2_f32_bf16 v21, v90, s7, v21
    v_dot2_f32_bf16 v22, v91, s6, v22
    v_dot2_f32_bf16 v23, v91, s7, v23
    v_dot2_f32_bf16 v24, v92, s6, v24
    v_dot2_f32_bf16 v25, v92, s7, v25
    v_dot2_f32_bf16 v26, v93, s6, v26
    v_dot2_f32_bf16 v27, v93, s7, v27
    v_dot2_f32_bf16 v28, v94, s6, v28
    v_dot2_f32_bf16 v29, v94, s7, v29
    v_dot2_f32_bf16 v30, v95, s6, v30
    v_dot2_f32_bf16 v31, v95, s7, v31
    s_waitcnt vmcnt(2)
    v_dot2_f32_bf16 v16, v96, s6, v16
    v_dot2_f32_bf16 v17, v96, s7, v17
    v_dot2_f32_bf16 v18, v97, s6, v18
    v_dot2_f32_bf16 v19, v97, s7, v19
    v_dot2_f32_bf16 v20, v98, s6, v20
    v_dot2_f32_bf16 v21, v98, s7, v21
    v_dot2_f32_bf16 v22, v99, s6, v22
    v_dot2_f32_bf16 v23, v99, s7, v23
    v_dot2_f32_bf16 v24, v100, s6, v24
    v_dot2_f32_bf16 v25, v100, s7, v25
    v_dot2_f32_bf16 v26, v101, s6, v26
    v_dot2_f32_bf16 v27, v101, s7, v27
    v_dot2_f32_bf16 v28, v102, s6, v28
    v_dot2_f32_bf16 v29, v102, s7, v29
    v_dot2_f32_bf16 v30, v103, s6, v30
    v_dot2_f32_bf16 v31, v103, s7, v31
    s_waitcnt vmcnt(0)
    v_dot2_f32_bf16 v16, v104, s6, v16
    v_dot2_f32_bf16 v17, v104, s7, v17
    v_dot2_f32_bf16 v18, v105, s6, v18
    v_dot2_f32_bf16 v19, v105, s7, v19
    v_dot2_f32_bf16 v20, v106, s6, v20
    v_dot2_f32_bf16 v21, v106, s7, v21
    v_dot2_f32_bf16 v22, v107, s6, v22
    v_dot2_f32_bf16 v23, v107, s7, v23
    v_dot2_f32_bf16 v24, v108, s6, v24
    v_dot2_f32_bf16 v25, v108, s7, v25
    v_dot2_f32_bf16 v26, v109, s6, v26
    v_dot2_f32_bf16 v27, v109, s7, v27
    v_dot2_f32_bf16 v28, v110, s6, v28
    v_dot2_f32_bf16 v29, v110, s7, v29
    v_dot2_f32_bf16 v30, v111, s6, v30
    v_dot2_f32_bf16 v31, v111, s7, v31
    s_nop 2
    v_pk_mul_f32 v[48:49], v[16:17], v[16:17]
    v_pk_mul_f32 v[50:51], v[18:19], v[18:19]
    v_pk_mul_f32 v[52:53], v[20:21], v[20:21]
    v_pk_mul_f32 v[54:55], v[22:23], v[22:23]
    v_pk_mul_f32 v[56:57], v[24:25], v[24:25]
    v_pk_mul_f32 v[58:59], v[26:27], v[26:27]
    v_pk_mul_f32 v[60:61], v[28:29], v[28:29]
    v_pk_mul_f32 v[62:63], v[30:31], v[30:31]
    v_pk_fma_f32 v[48:49], v[48:49], s[10:11], v[32:33]
    v_pk_fma_f32 v[50:51], v[50:51], s[10:11], v[32:33]
    v_pk_fma_f32 v[52:53], v[52:53], s[10:11], v[32:33]
    v_pk_fma_f32 v[54:55], v[54:55], s[10:11], v[32:33]
    v_pk_fma_f32 v[56:57], v[56:57], s[10:11], v[32:33]
    v_pk_fma_f32 v[58:59], v[58:59], s[10:11], v[32:33]
    v_pk_fma_f32 v[60:61], v[60:61], s[10:11], v[32:33]
    v_pk_fma_f32 v[62:63], v[62:63], s[10:11], v[32:33]
    v_pk_mul_f32 v[48:49], v[48:49], v[16:17]
    v_pk_mul_f32 v[50:51], v[50:51], v[18:19]
    v_pk_mul_f32 v[52:53], v[52:53], v[20:21]
    v_pk_mul_f32 v[54:55], v[54:55], v[22:23]
    v_pk_mul_f32 v[56:57], v[56:57], v[24:25]
    v_pk_mul_f32 v[58:59], v[58:59], v[26:27]
    v_pk_mul_f32 v[60:61], v[60:61], v[28:29]
    v_pk_mul_f32 v[62:63], v[62:63], v[30:31]
    v_exp_f32 v48, v48
    v_exp_f32 v49, v49
    v_exp_f32 v50, v50
    v_exp_f32 v51, v51
    v_exp_f32 v52, v52
    v_exp_f32 v53, v53
    v_exp_f32 v54, v54
    v_exp_f32 v55, v55
    v_exp_f32 v56, v56
    v_exp_f32 v57, v57
    v_exp_f32 v58, v58
    v_exp_f32 v59, v59
    v_exp_f32 v60, v60
    v_exp_f32 v61, v61
    v_exp_f32 v62, v62
    v_exp_f32 v63, v63
    v_pk_add_f32 v[48:49], v[48:49], 1.0 op_sel_hi:[1,0]
    v_pk_add_f32 v[50:51], v[50:51], 1.0 op_sel_hi:[1,0]
    v_pk_add_f32 v[52:53], v[52:53], 1.0 op_sel_hi:[1,0]
    v_pk_add_f32 v[54:55], v[54:55], 1.0 op_sel_hi:[1,0]
    v_pk_add_f32 v[56:57], v[56:57], 1.0 op_sel_hi:[1,0]
    v_pk_add_f32 v[58:59], v[58:59], 1.0 op_sel_hi:[1,0]
    v_pk_add_f32 v[60:61], v[60:61], 1.0 op_sel_hi:[1,0]
    v_pk_add_f32 v[62:63], v[62:63], 1.0 op_sel_hi:[1,0]
    v_rcp_f32 v48, v48
    v_rcp_f32 v49, v49
    v_rcp_f32 v50, v50
    v_rcp_f32 v51, v51
    v_rcp_f32 v52, v52
    v_rcp_f32 v53, v53
    v_rcp_f32 v54, v54
    v_rcp_f32 v55, v55
    v_rcp_f32 v56, v56
    v_rcp_f32 v57, v57
    v_rcp_f32 v58, v58
    v_rcp_f32 v59, v59
    v_rcp_f32 v60, v60
    v_rcp_f32 v61, v61
    v_rcp_f32 v62, v62
    v_rcp_f32 v63, v63
    v_pk_mul_f32 v[16:17], v[16:17], v[48:49]
    v_pk_mul_f32 v[18:19], v[18:19], v[50:51]
    v_pk_mul_f32 v[20:21], v[20:21], v[52:53]
    v_pk_mul_f32 v[22:23], v[22:23], v[54:55]
    v_pk_mul_f32 v[24:25], v[24:25], v[56:57]
    v_pk_mul_f32 v[26:27], v[26:27], v[58:59]
    v_pk_mul_f32 v[28:29], v[28:29], v[60:61]
    v_pk_mul_f32 v[30:31], v[30:31], v[62:63]
    v_cvt_pk_bf16_f32 v32, v16, v17
    v_cvt_pk_bf16_f32 v33, v18, v19
    v_cvt_pk_bf16_f32 v34, v20, v21
    v_cvt_pk_bf16_f32 v35, v22, v23
    v_cvt_pk_bf16_f32 v36, v24, v25
    v_cvt_pk_bf16_f32 v37, v26, v27
    v_cvt_pk_bf16_f32 v38, v28, v29
    v_cvt_pk_bf16_f32 v39, v30, v31
    s_lshl_b32 s4, s27, 1
    s_lshr_b32 s5, s28, 1
    s_add_u32 s4, s4, s5
    s_and_b32 s5, s28, 1
    s_mul_i32 s10, s4, 180224
    s_lshl_b32 s31, s29, 12
    s_add_u32 s10, s10, s31
    s_lshl_b32 s31, s5, 10
    s_add_u32 s10, s10, s31
    s_add_u32 s10, s10, 8388608
    buffer_store_dwordx4 v[32:35], v14, s[20:23], s10 offen sc1
    buffer_store_dwordx4 v[36:39], v14, s[20:23], s10 offen offset:2048 sc1
    s_lshl_b32 s10, s4, 14
    s_lshl_b32 s31, s29, 8
    s_add_u32 s10, s10, s31
    s_lshl_b32 s31, s5, 7
    s_add_u32 s10, s10, s31
    s_add_u32 s10, s10, 12779520
    v_lshlrev_b32 v129, 2, v2
    v_mov_b32 v130, s35
    s_waitcnt vmcnt(0)
    s_mov_b32 exec_hi, 0
    buffer_store_dword v130, v129, s[20:23], s10 offen sc1
    s_mov_b64 exec, -1
    s_branch L_m_g2
L_m_skipred:
L_m_g2:
    s_mov_b64 exec, 1
    ds_add_u32 v8, v9 offset:144
    s_mov_b64 exec, -1
    s_lshl_b32 s26, s24, 2
    s_lshr_b32 s27, s25, 3
    s_add_u32 s26, s26, s27
    s_and_b32 s27, s25, 7
    s_mov_b32 s16, s50
    s_and_b32 s17, s51, 0xffff
    s_mov_b32 s18, 0x1000
    s_mov_b32 s19, 0x00020000
    s_mul_i32 s28, s33, 1441792
    s_lshl_b32 s31, s26, 7
    s_add_u32 s28, s28, s31
    s_mul_i32 s29, s27, 180224
    s_mul_i32 s31, s33, 45056
    s_add_u32 s29, s29, s31
    s_add_u32 s29, s29, 8388608
    s_lshl_b32 s10, s9, 6
    s_lshl_b32 s31, s8, 10
    v_xor_b32 v3, s31, v14
    v_xor_b32 v4, 1024, v3
    v_lshrrev_b32 v128, 3, v2
    v_mul_u32_u24 v5, 4096, v128
    v_bfe_u32 v128, v2, 4, 1
    v_lshlrev_b32 v128, 2, v128
    v_and_b32 v129, 7, v2
    v_xor_b32 v128, v128, v129
    v_lshl_add_u32 v5, v128, 4, v5
    v_bfe_u32 v128, v2, 2, 2
    v_lshrrev_b32 v129, 5, v2
    v_lshl_add_u32 v129, v129, 2, v128
    v_lshlrev_b32 v129, 7, v129
    v_bfe_u32 v130, v2, 4, 1
    v_lshl_add_u32 v129, v130, 5, v129
    v_and_b32 v130, 3, v2
    v_lshl_add_u32 v129, v130, 3, v129
    v_lshrrev_b32 v130, 1, v128
    v_lshl_add_u32 v129, v130, 6, v129
    v_xor_b32 v129, s10, v129
    v_add_u32 v6, s30, v129
    v_xor_b32 v129, 64, v129
    v_add_u32 v7, s30, v129
L_gated__lw_47:
    ds_read_b32 v128, v8 offset:144
    s_waitcnt lgkmcnt(0)
    v_readfirstlane_b32 s4, v128
    s_cmp_ge_u32 s4, 4
    s_cbranch_scc1 L_gated__lwd_48
    s_sleep 3
    s_branch L_gated__lw_47
L_gated__lwd_48:
    s_cmp_ge_u32 s33, 2
    s_cbranch_scc1 L_m_uw
    v_min_u32 v15, 43, v2
    v_lshlrev_b32 v15, 7, v15
    s_lshl_b32 s10, s27, 14
    s_mul_i32 s31, s33, 5632
    s_add_u32 s10, s10, s31
    s_add_u32 s10, s10, 12779520
    s_mov_b32 s5, 0
L_gated__fp_49:
    buffer_load_dword v128, v15, s[20:23], s10 offen sc1
    s_add_u32 s5, s5, 1
    s_waitcnt vmcnt(0)
    v_cmp_ne_u32 vcc, s35, v128
    s_and_b64 exec, exec, vcc
    s_cbranch_scc0 L_gated__fpd_50
    s_sleep 4
    s_cmp_lt_u32 s5, 262144
    s_cbranch_scc1 L_gated__fp_49
L_gated__fpd_50:
    s_mov_b64 exec, -1
    s_mov_b64 exec, 1
    ds_add_u32 v8, v9 offset:148
    s_mov_b64 exec, -1
L_m_uw:
L_gated__lw_51:
    ds_read_b32 v128, v8 offset:148
    s_waitcnt lgkmcnt(0)
    v_readfirstlane_b32 s4, v128
    s_cmp_ge_u32 s4, 2
    s_cbranch_scc1 L_gated__lwd_52
    s_sleep 2
    s_branch L_gated__lw_51
L_gated__lwd_52:
    s_setprio 0
    s_add_u32 m0, s30, 0
    s_add_u32 s31, s28, 32768
    buffer_load_dwordx4 v5, s[60:63], s28 offen lds
    s_add_u32 m0, s30, 1024
    s_add_u32 s28, s28, 65536
    buffer_load_dwordx4 v5, s[60:63], s31 offen lds
    buffer_load_dwordx4 v[80:83], v3, s[20:23], s29 offen sc1
    buffer_load_dwordx4 v[84:87], v4, s[20:23], s29 offen sc1
    s_add_u32 s29, s29, 2048
    s_add_u32 m0, s30, 2048
    s_add_u32 s31, s28, 32768
    buffer_load_dwordx4 v5, s[60:63], s28 offen lds
    s_add_u32 m0, s30, 3072
    s_add_u32 s28, s28, 65536
    buffer_load_dwordx4 v5, s[60:63], s31 offen lds
    buffer_load_dwordx4 v[88:91], v3, s[20:23], s29 offen sc1
    buffer_load_dwordx4 v[92:95], v4, s[20:23], s29 offen sc1
    s_add_u32 s29, s29, 2048
    s_add_u32 m0, s30, 4096
    s_add_u32 s31, s28, 32768
    buffer_load_dwordx4 v5, s[60:63], s28 offen lds
    s_add_u32 m0, s30, 5120
    s_add_u32 s28, s28, 65536
    buffer_load_dwordx4 v5, s[60:63], s31 offen lds
    buffer_load_dwordx4 v[96:99], v3, s[20:23], s29 offen sc1
    buffer_load_dwordx4 v[100:103], v4, s[20:23], s29 offen sc1
    s_add_u32 s29, s29, 2048
    s_waitcnt vmcnt(10)
    ds_read_b64_tr_b16 v[112:113], v6 offset:0
    ds_read_b64_tr_b16 v[114:115], v6 offset:1024
    ds_read_b64_tr_b16 v[116:117], v7 offset:0
    ds_read_b64_tr_b16 v[118:119], v7 offset:1024
    s_waitcnt lgkmcnt(0)
    s_add_u32 m0, s30, 0
    s_add_u32 s31, s28, 32768
    buffer_load_dwordx4 v5, s[60:63], s28 offen lds
    s_add_u32 m0, s30, 1024
    s_add_u32 s28, s28, 65536
    buffer_load_dwordx4 v5, s[60:63], s31 offen lds
    buffer_load_dwordx4 v[104:107], v3, s[20:23], s29 offen sc1
    buffer_load_dwordx4 v[108:111], v4, s[20:23], s29 offen sc1
    s_add_u32 s29, s29, 2048
    s_waitcnt vmcnt(10)
    ds_read_b64_tr_b16 v[120:121], v6 offset:2048
    ds_read_b64_tr_b16 v[122:123], v6 offset:3072
    ds_read_b64_tr_b16 v[124:125], v7 offset:2048
    ds_read_b64_tr_b16 v[126:127], v7 offset:3072
    v_mfma_f32_32x32x16_bf16 v[16:31], v[80:83], v[112:115], 0
    s_waitcnt lgkmcnt(0)
    v_mfma_f32_32x32x16_bf16 v[32:47], v[80:83], v[116:119], 0
    s_add_u32 m0, s30, 2048
    s_add_u32 s31, s28, 32768
    buffer_load_dwordx4 v5, s[60:63], s28 offen lds
    v_mfma_f32_32x32x16_bf16 v[48:63], v[84:87], v[112:115], 0
    s_add_u32 m0, s30, 3072
    s_add_u32 s28, s28, 65536
    buffer_load_dwordx4 v5, s[60:63], s31 offen lds
    v_mfma_f32_32x32x16_bf16 v[64:79], v[84:87], v[116:119], 0
    buffer_load_dwordx4 v[80:83], v3, s[20:23], s29 offen sc1
    buffer_load_dwordx4 v[84:87], v4, s[20:23], s29 offen sc1
    s_add_u32 s29, s29, 2048
    s_waitcnt vmcnt(10)
    ds_read_b64_tr_b16 v[112:113], v6 offset:4096
    ds_read_b64_tr_b16 v[114:115], v6 offset:5120
    ds_read_b64_tr_b16 v[116:117], v7 offset:4096
    ds_read_b64_tr_b16 v[118:119], v7 offset:5120
    v_mfma_f32_32x32x16_bf16 v[16:31], v[88:91], v[120:123], v[16:31]
    s_waitcnt lgkmcnt(0)
    v_mfma_f32_32x32x16_bf16 v[32:47], v[88:91], v[124:127], v[32:47]
    s_add_u32 m0, s30, 4096
    s_add_u32 s31, s28, 32768
    buffer_load_dwordx4 v5, s[60:63], s28 offen lds
    v_mfma_f32_32x32x16_bf16 v[48:63], v[92:95], v[120:123], v[48:63]
    s_add_u32 m0, s30, 5120
    s_add_u32 s28, s28, 65536
    buffer_load_dwordx4 v5, s[60:63], s31 offen lds
    v_mfma_f32_32x32x16_bf16 v[64:79], v[92:95], v[124:127], v[64:79]
    buffer_load_dwordx4 v[88:91], v3, s[20:23], s29 offen sc1
    buffer_load_dwordx4 v[92:95], v4, s[20:23], s29 offen sc1
    s_add_u32 s29, s29, 2048
    s_waitcnt vmcnt(10)
    ds_read_b64_tr_b16 v[120:121], v6 offset:0
    ds_read_b64_tr_b16 v[122:123], v6 offset:1024
    ds_read_b64_tr_b16 v[124:125], v7 offset:0
    ds_read_b64_tr_b16 v[126:127], v7 offset:1024
    v_mfma_f32_32x32x16_bf16 v[16:31], v[96:99], v[112:115], v[16:31]
    s_waitcnt lgkmcnt(0)
    v_mfma_f32_32x32x16_bf16 v[32:47], v[96:99], v[116:119], v[32:47]
    s_add_u32 m0, s30, 0
    s_add_u32 s31, s28, 32768
    buffer_load_dwordx4 v5, s[60:63], s28 offen lds
    v_mfma_f32_32x32x16_bf16 v[48:63], v[100:103], v[112:115], v[48:63]
    s_add_u32 m0, s30, 1024
    s_add_u32 s28, s28, 65536
    buffer_load_dwordx4 v5, s[60:63], s31 offen lds
    v_mfma_f32_32x32x16_bf16 v[64:79], v[100:103], v[116:119], v[64:79]
    buffer_load_dwordx4 v[96:99], v3, s[20:23], s29 offen sc1
    buffer_load_dwordx4 v[100:103], v4, s[20:23], s29 offen sc1
    s_add_u32 s29, s29, 2048
    s_waitcnt vmcnt(10)
    ds_read_b64_tr_b16 v[112:113], v6 offset:2048
    ds_read_b64_tr_b16 v[114:115], v6 offset:3072
    ds_read_b64_tr_b16 v[116:117], v7 offset:2048
    ds_read_b64_tr_b16 v[118:119], v7 offset:3072
    v_mfma_f32_32x32x16_bf16 v[16:31], v[104:107], v[120:123], v[16:31]
    s_waitcnt lgkmcnt(0)
    v_mfma_f32_32x32x16_bf16 v[32:47], v[104:107], v[124:127], v[32:47]
    s_add_u32 m0, s30, 2048
    s_add_u32 s31, s28, 32768
    buffer_load_dwordx4 v5, s[60:63], s28 offen lds
    v_mfma_f32_32x32x16_bf16 v[48:63], v[108:111], v[120:123], v[48:63]
    s_add_u32 m0, s30, 3072
    s_add_u32 s28, s28, 65536
    buffer_load_dwordx4 v5, s[60:63], s31 offen lds
    v_mfma_f32_32x32x16_bf16 v[64:79], v[108:111], v[124:127], v[64:79]
    buffer_load_dwordx4 v[104:107], v3, s[20:23], s29 offen sc1
    buffer_load_dwordx4 v[108:111], v4, s[20:23], s29 offen sc1
    s_add_u32 s29, s29, 2048
    s_waitcnt vmcnt(10)
    ds_read_b64_tr_b16 v[120:121], v6 offset:4096
    ds_read_b64_tr_b16 v[122:123], v6 offset:5120
    ds_read_b64_tr_b16 v[124:125], v7 offset:4096
    ds_read_b64_tr_b16 v[126:127], v7 offset:5120
    v_mfma_f32_32x32x16_bf16 v[16:31], v[80:83], v[112:115], v[16:31]
    s_waitcnt lgkmcnt(0)
    v_mfma_f32_32x32x16_bf16 v[32:47], v[80:83], v[116:119], v[32:47]
    s_add_u32 m0, s30, 4096
    s_add_u32 s31, s28, 32768
    buffer_load_dwordx4 v5, s[60:63], s28 offen lds
    v_mfma_f32_32x32x16_bf16 v[48:63], v[84:87], v[112:115], v[48:63]
    s_add_u32 m0, s30, 5120
    s_add_u32 s28, s28, 65536
    buffer_load_dwordx4 v5, s[60:63], s31 offen lds
    v_mfma_f32_32x32x16_bf16 v[64:79], v[84:87], v[116:119], v[64:79]
    buffer_load_dwordx4 v[80:83], v3, s[20:23], s29 offen sc1
    buffer_load_dwordx4 v[84:87], v4, s[20:23], s29 offen sc1
    s_add_u32 s29, s29, 2048
    s_waitcnt vmcnt(10)
    ds_read_b64_tr_b16 v[112:113], v6 offset:0
    ds_read_b64_tr_b16 v[114:115], v6 offset:1024
    ds_read_b64_tr_b16 v[116:117], v7 offset:0
    ds_read_b64_tr_b16 v[118:119], v7 offset:1024
    v_mfma_f32_32x32x16_bf16 v[16:31], v[88:91], v[120:123], v[16:31]
    s_waitcnt lgkmcnt(0)
    v_mfma_f32_32x32x16_bf16 v[32:47], v[88:91], v[124:127], v[32:47]
    s_add_u32 m0, s30, 0
    s_add_u32 s31, s28, 32768
    buffer_load_dwordx4 v5, s[60:63], s28 offen lds
    v_mfma_f32_32x32x16_bf16 v[48:63], v[92:95], v[120:123], v[48:63]
    s_add_u32 m0, s30, 1024
    s_add_u32 s28, s28, 65536
    buffer_load_dwordx4 v5, s[60:63], s31 offen lds
    v_mfma_f32_32x32x16_bf16 v[64:79], v[92:95], v[124:127], v[64:79]
    buffer_load_dwordx4 v[88:91], v3, s[20:23], s29 offen sc1
    buffer_load_dwordx4 v[92:95], v4, s[20:23], s29 offen sc1
    s_add_u32 s29, s29, 2048
    s_waitcnt vmcnt(10)
    ds_read_b64_tr_b16 v[120:121], v6 offset:2048
    ds_read_b64_tr_b16 v[122:123], v6 offset:3072
    ds_read_b64_tr_b16 v[124:125], v7 offset:2048
    ds_read_b64_tr_b16 v[126:127], v7 offset:3072
    v_mfma_f32_32x32x16_bf16 v[16:31], v[96:99], v[112:115], v[16:31]
    s_waitcnt lgkmcnt(0)
    v_mfma_f32_32x32x16_bf16 v[32:47], v[96:99], v[116:119], v[32:47]
    s_add_u32 m0, s30, 2048
    s_add_u32 s31, s28, 32768
    buffer_load_dwordx4 v5, s[60:63], s28 offen lds
    v_mfma_f32_32x32x16_bf16 v[48:63], v[100:103], v[112:115], v[48:63]
    s_add_u32 m0, s30, 3072
    s_add_u32 s28, s28, 65536
    buffer_load_dwordx4 v5, s[60:63], s31 offen lds
    v_mfma_f32_32x32x16_bf16 v[64:79], v[100:103], v[116:119], v[64:79]
    buffer_load_dwordx4 v[96:99], v3, s[20:23], s29 offen sc1
    buffer_load_dwordx4 v[100:103], v4, s[20:23], s29 offen sc1
    s_add_u32 s29, s29, 2048
    s_waitcnt vmcnt(10)
    ds_read_b64_tr_b16 v[112:113], v6 offset:4096
    ds_read_b64_tr_b16 v[114:115], v6 offset:5120
    ds_read_b64_tr_b16 v[116:117], v7 offset:4096
    ds_read_b64_tr_b16 v[118:119], v7 offset:5120
    v_mfma_f32_32x32x16_bf16 v[16:31], v[104:107], v[120:123], v[16:31]
    s_waitcnt lgkmcnt(0)
    v_mfma_f32_32x32x16_bf16 v[32:47], v[104:107], v[124:127], v[32:47]
    s_add_u32 m0, s30, 4096
    s_add_u32 s31, s28, 32768
    buffer_load_dwordx4 v5, s[60:63], s28 offen lds
    v_mfma_f32_32x32x16_bf16 v[48:63], v[108:111], v[120:123], v[48:63]
    s_add_u32 m0, s30, 5120
    s_add_u32 s28, s28, 65536
    buffer_load_dwordx4 v5, s[60:63], s31 offen lds
    v_mfma_f32_32x32x16_bf16 v[64:79], v[108:111], v[124:127], v[64:79]
    buffer_load_dwordx4 v[104:107], v3, s[20:23], s29 offen sc1
    buffer_load_dwordx4 v[108:111], v4, s[20:23], s29 offen sc1
    s_add_u32 s29, s29, 2048
    s_waitcnt vmcnt(10)
    ds_read_b64_tr_b16 v[120:121], v6 offset:0
    ds_read_b64_tr_b16 v[122:123], v6 offset:1024
    ds_read_b64_tr_b16 v[124:125], v7 offset:0
    ds_read_b64_tr_b16 v[126:127], v7 offset:1024
    v_mfma_f32_32x32x16_bf16 v[16:31], v[80:83], v[112:115], v[16:31]
    s_waitcnt lgkmcnt(0)
    v_mfma_f32_32x32x16_bf16 v[32:47], v[80:83], v[116:119], v[32:47]
    s_add_u32 m0, s30, 0
    s_add_u32 s31, s28, 32768
    buffer_load_dwordx4 v5, s[60:63], s28 offen lds
    v_mfma_f32_32x32x16_bf16 v[48:63], v[84:87], v[112:115], v[48:63]
    s_add_u32 m0, s30, 1024
    s_add_u32 s28, s28, 65536
    buffer_load_dwordx4 v5, s[60:63], s31 offen lds
    v_mfma_f32_32x32x16_bf16 v[64:79], v[84:87], v[116:119], v[64:79]
    buffer_load_dwordx4 v[80:83], v3, s[20:23], s29 offen sc1
    buffer_load_dwordx4 v[84:87], v4, s[20:23], s29 offen sc1
    s_add_u32 s29, s29, 2048
    s_waitcnt vmcnt(10)
    ds_read_b64_tr_b16 v[112:113], v6 offset:2048
    ds_read_b64_tr_b16 v[114:115], v6 offset:3072
    ds_read_b64_tr_b16 v[116:117], v7 offset:2048
    ds_read_b64_tr_b16 v[118:119], v7 offset:3072
    v_mfma_f32_32x32x16_bf16 v[16:31], v[88:91], v[120:123], v[16:31]
    s_waitcnt lgkmcnt(0)
    v_mfma_f32_32x32x16_bf16 v[32:47], v[88:91], v[124:127], v[32:47]
    s_add_u32 m0, s30, 2048
    s_add_u32 s31, s28, 32768
    buffer_load_dwordx4 v5, s[60:63], s28 offen lds
    v_mfma_f32_32x32x16_bf16 v[48:63], v[92:95], v[120:123], v[48:63]
    s_add_u32 m0, s30, 3072
    s_add_u32 s28, s28, 65536
    buffer_load_dwordx4 v5, s[60:63], s31 offen lds
    v_mfma_f32_32x32x16_bf16 v[64:79], v[92:95], v[124:127], v[64:79]
    buffer_load_dwordx4 v[88:91], v3, s[20:23], s29 offen sc1
    buffer_load_dwordx4 v[92:95], v4, s[20:23], s29 offen sc1
    s_add_u32 s29, s29, 2048
    s_waitcnt vmcnt(10)
    ds_read_b64_tr_b16 v[120:121], v6 offset:4096
    ds_read_b64_tr_b16 v[122:123], v6 offset:5120
    ds_read_b64_tr_b16 v[124:125], v7 offset:4096
    ds_read_b64_tr_b16 v[126:127], v7 offset:5120
    v_mfma_f32_32x32x16_bf16 v[16:31], v[96:99], v[112:115], v[16:31]
    s_waitcnt lgkmcnt(0)
    v_mfma_f32_32x32x16_bf16 v[32:47], v[96:99], v[116:119], v[32:47]
    s_add_u32 m0, s30, 4096
    s_add_u32 s31, s28, 32768
    buffer_load_dwordx4 v5, s[60:63], s28 offen lds
    v_mfma_f32_32x32x16_bf16 v[48:63], v[100:103], v[112:115], v[48:63]
    s_add_u32 m0, s30, 5120
    s_add_u32 s28, s28, 65536
    buffer_load_dwordx4 v5, s[60:63], s31 offen lds
    v_mfma_f32_32x32x16_bf16 v[64:79], v[100:103], v[116:119], v[64:79]
    buffer_load_dwordx4 v[96:99], v3, s[20:23], s29 offen sc1
    buffer_load_dwordx4 v[100:103], v4, s[20:23], s29 offen sc1
    s_add_u32 s29, s29, 2048
    s_waitcnt vmcnt(10)
    ds_read_b64_tr_b16 v[112:113], v6 offset:0
    ds_read_b64_tr_b16 v[114:115], v6 offset:1024
    ds_read_b64_tr_b16 v[116:117], v7 offset:0
    ds_read_b64_tr_b16 v[118:119], v7 offset:1024
    v_mfma_f32_32x32x16_bf16 v[16:31], v[104:107], v[120:123], v[16:31]
    s_waitcnt lgkmcnt(0)
    v_mfma_f32_32x32x16_bf16 v[32:47], v[104:107], v[124:127], v[32:47]
    s_add_u32 m0, s30, 0
    s_add_u32 s31, s28, 32768
    buffer_load_dwordx4 v5, s[60:63], s28 offen lds
    v_mfma_f32_32x32x16_bf16 v[48:63], v[108:111], v[120:123], v[48:63]
    s_add_u32 m0, s30, 1024
    s_add_u32 s28, s28, 65536
    buffer_load_dwordx4 v5, s[60:63], s31 offen lds
    v_mfma_f32_32x32x16_bf16 v[64:79], v[108:111], v[124:127], v[64:79]
    buffer_load_dwordx4 v[104:107], v3, s[20:23], s29 offen sc1
    buffer_load_dwordx4 v[108:111], v4, s[20:23], s29 offen sc1
    s_add_u32 s29, s29, 2048
    s_waitcnt vmcnt(10)
    ds_read_b64_tr_b16 v[120:121], v6 offset:2048
    ds_read_b64_tr_b16 v[122:123], v6 offset:3072
    ds_read_b64_tr_b16 v[124:125], v7 offset:2048
    ds_read_b64_tr_b16 v[126:127], v7 offset:3072
    v_mfma_f32_32x32x16_bf16 v[16:31], v[80:83], v[112:115], v[16:31]
    s_waitcnt lgkmcnt(0)
    v_mfma_f32_32x32x16_bf16 v[32:47], v[80:83], v[116:119], v[32:47]
    s_add_u32 m0, s30, 2048
    s_add_u32 s31, s28, 32768
    buffer_load_dwordx4 v5, s[60:63], s28 offen lds
    v_mfma_f32_32x32x16_bf16 v[48:63], v[84:87], v[112:115], v[48:63]
    s_add_u32 m0, s30, 3072
    s_add_u32 s28, s28, 65536
    buffer_load_dwordx4 v5, s[60:63], s31 offen lds
    v_mfma_f32_32x32x16_bf16 v[64:79], v[84:87], v[116:119], v[64:79]
    buffer_load_dwordx4 v[80:83], v3, s[20:23], s29 offen sc1
    buffer_load_dwordx4 v[84:87], v4, s[20:23], s29 offen sc1
    s_add_u32 s29, s29, 2048
    s_waitcnt vmcnt(10)
    ds_read_b64_tr_b16 v[112:113], v6 offset:4096
    ds_read_b64_tr_b16 v[114:115], v6 offset:5120
    ds_read_b64_tr_b16 v[116:117], v7 offset:4096
    ds_read_b64_tr_b16 v[118:119], v7 offset:5120
    v_mfma_f32_32x32x16_bf16 v[16:31], v[88:91], v[120:123], v[16:31]
    s_waitcnt lgkmcnt(0)
    v_mfma_f32_32x32x16_bf16 v[32:47], v[88:91], v[124:127], v[32:47]
    s_add_u32 m0, s30, 4096
    s_add_u32 s31, s28, 32768
    buffer_load_dwordx4 v5, s[60:63], s28 offen lds
    v_mfma_f32_32x32x16_bf16 v[48:63], v[92:95], v[120:123], v[48:63]
    s_add_u32 m0, s30, 5120
    s_add_u32 s28, s28, 65536
    buffer_load_dwordx4 v5, s[60:63], s31 offen lds
    v_mfma_f32_32x32x16_bf16 v[64:79], v[92:95], v[124:127], v[64:79]
    buffer_load_dwordx4 v[88:91], v3, s[20:23], s29 offen sc1
    buffer_load_dwordx4 v[92:95], v4, s[20:23], s29 offen sc1
    s_add_u32 s29, s29, 2048
    s_waitcnt vmcnt(10)
    ds_read_b64_tr_b16 v[120:121], v6 offset:0
    ds_read_b64_tr_b16 v[122:123], v6 offset:1024
    ds_read_b64_tr_b16 v[124:125], v7 offset:0
    ds_read_b64_tr_b16 v[126:127], v7 offset:1024
    v_mfma_f32_32x32x16_bf16 v[16:31], v[96:99], v[112:115], v[16:31]
    s_waitcnt lgkmcnt(0)
    v_mfma_f32_32x32x16_bf16 v[32:47], v[96:99], v[116:119], v[32:47]
    s_add_u32 m0, s30, 0
    s_add_u32 s31, s28, 32768
    buffer_load_dwordx4 v5, s[60:63], s28 offen lds
    v_mfma_f32_32x32x16_bf16 v[48:63], v[100:103], v[112:115], v[48:63]
    s_add_u32 m0, s30, 1024
    s_add_u32 s28, s28, 65536
    buffer_load_dwordx4 v5, s[60:63], s31 offen lds
    v_mfma_f32_32x32x16_bf16 v[64:79], v[100:103], v[116:119], v[64:79]
    buffer_load_dwordx4 v[96:99], v3, s[20:23], s29 offen sc1
    buffer_load_dwordx4 v[100:103], v4, s[20:23], s29 offen sc1
    s_add_u32 s29, s29, 2048
    s_waitcnt vmcnt(10)
    ds_read_b64_tr_b16 v[112:113], v6 offset:2048
    ds_read_b64_tr_b16 v[114:115], v6 offset:3072
    ds_read_b64_tr_b16 v[116:117], v7 offset:2048
    ds_read_b64_tr_b16 v[118:119], v7 offset:3072
    v_mfma_f32_32x32x16_bf16 v[16:31], v[104:107], v[120:123], v[16:31]
    s_waitcnt lgkmcnt(0)
    v_mfma_f32_32x32x16_bf16 v[32:47], v[104:107], v[124:127], v[32:47]
    s_add_u32 m0, s30, 2048
    s_add_u32 s31, s28, 32768
    buffer_load_dwordx4 v5, s[60:63], s28 offen lds
    v_mfma_f32_32x32x16_bf16 v[48:63], v[108:111], v[120:123], v[48:63]
    s_add_u32 m0, s30, 3072
    s_add_u32 s28, s28, 65536
    buffer_load_dwordx4 v5, s[60:63], s31 offen lds
    v_mfma_f32_32x32x16_bf16 v[64:79], v[108:111], v[124:127], v[64:79]
    buffer_load_dwordx4 v[104:107], v3, s[20:23], s29 offen sc1
    buffer_load_dwordx4 v[108:111], v4, s[20:23], s29 offen sc1
    s_add_u32 s29, s29, 2048
    s_waitcnt vmcnt(10)
    ds_read_b64_tr_b16 v[120:121], v6 offset:4096
    ds_read_b64_tr_b16 v[122:123], v6 offset:5120
    ds_read_b64_tr_b16 v[124:125], v7 offset:4096
    ds_read_b64_tr_b16 v[126:127], v7 offset:5120
    v_mfma_f32_32x32x16_bf16 v[16:31], v[80:83], v[112:115], v[16:31]
    s_waitcnt lgkmcnt(0)
    v_mfma_f32_32x32x16_bf16 v[32:47], v[80:83], v[116:119], v[32:47]
    s_add_u32 m0, s30, 4096
    s_add_u32 s31, s28, 32768
    buffer_load_dwordx4 v5, s[60:63], s28 offen lds
    v_mfma_f32_32x32x16_bf16 v[48:63], v[84:87], v[112:115], v[48:63]
    s_add_u32 m0, s30, 5120
    s_add_u32 s28, s28, 65536
    buffer_load_dwordx4 v5, s[60:63], s31 offen lds
    v_mfma_f32_32x32x16_bf16 v[64:79], v[84:87], v[116:119], v[64:79]
    buffer_load_dwordx4 v[80:83], v3, s[20:23], s29 offen sc1
    buffer_load_dwordx4 v[84:87], v4, s[20:23], s29 offen sc1
    s_add_u32 s29, s29, 2048
    s_waitcnt vmcnt(10)
    ds_read_b64_tr_b16 v[112:113], v6 offset:0
    ds_read_b64_tr_b16 v[114:115], v6 offset:1024
    ds_read_b64_tr_b16 v[116:117], v7 offset:0
    ds_read_b64_tr_b16 v[118:119], v7 offset:1024
    v_mfma_f32_32x32x16_bf16 v[16:31], v[88:91], v[120:123], v[16:31]
    s_waitcnt lgkmcnt(0)
    v_mfma_f32_32x32x16_bf16 v[32:47], v[88:91], v[124:127], v[32:47]
    s_add_u32 m0, s30, 0
    s_add_u32 s31, s28, 32768
    buffer_load_dwordx4 v5, s[60:63], s28 offen lds
    v_mfma_f32_32x32x16_bf16 v[48:63], v[92:95], v[120:123], v[48:63]
    s_add_u32 m0, s30, 1024
    s_add_u32 s28, s28, 65536
    buffer_load_dwordx4 v5, s[60:63], s31 offen lds
    v_mfma_f32_32x32x16_bf16 v[64:79], v[92:95], v[124:127], v[64:79]
    buffer_load_dwordx4 v[88:91], v3, s[20:23], s29 offen sc1
    buffer_load_dwordx4 v[92:95], v4, s[20:23], s29 offen sc1
    s_add_u32 s29, s29, 2048
    s_waitcnt vmcnt(10)
    ds_read_b64_tr_b16 v[120:121], v6 offset:2048
    ds_read_b64_tr_b16 v[122:123], v6 offset:3072
    ds_read_b64_tr_b16 v[124:125], v7 offset:2048
    ds_read_b64_tr_b16 v[126:127], v7 offset:3072
    v_mfma_f32_32x32x16_bf16 v[16:31], v[96:99], v[112:115], v[16:31]
    s_waitcnt lgkmcnt(0)
    v_mfma_f32_32x32x16_bf16 v[32:47], v[96:99], v[116:119], v[32:47]
    v_mfma_f32_32x32x16_bf16 v[48:63], v[100:103], v[112:115], v[48:63]
    v_mfma_f32_32x32x16_bf16 v[64:79], v[100:103], v[116:119], v[64:79]
    s_mov_b64 exec, 1
    ds_add_u32 v8, v9 offset:80
    s_mov_b64 exec, -1
    s_waitcnt vmcnt(6)
    ds_read_b64_tr_b16 v[112:113], v6 offset:4096
    ds_read_b64_tr_b16 v[114:115], v6 offset:5120
    ds_read_b64_tr_b16 v[116:117], v7 offset:4096
    ds_read_b64_tr_b16 v[118:119], v7 offset:5120
    v_mfma_f32_32x32x16_bf16 v[16:31], v[104:107], v[120:123], v[16:31]
    s_waitcnt lgkmcnt(0)
    v_mfma_f32_32x32x16_bf16 v[32:47], v[104:107], v[124:127], v[32:47]
    v_mfma_f32_32x32x16_bf16 v[48:63], v[108:111], v[120:123], v[48:63]
    v_mfma_f32_32x32x16_bf16 v[64:79], v[108:111], v[124:127], v[64:79]
    s_waitcnt vmcnt(2)
    ds_read_b64_tr_b16 v[120:121], v6 offset:0
    ds_read_b64_tr_b16 v[122:123], v6 offset:1024
    ds_read_b64_tr_b16 v[124:125], v7 offset:0
    ds_read_b64_tr_b16 v[126:127], v7 offset:1024
    v_mfma_f32_32x32x16_bf16 v[16:31], v[80:83], v[112:115], v[16:31]
    s_waitcnt lgkmcnt(0)
    v_mfma_f32_32x32x16_bf16 v[32:47], v[80:83], v[116:119], v[32:47]
    v_mfma_f32_32x32x16_bf16 v[48:63], v[84:87], v[112:115], v[48:63]
    v_mfma_f32_32x32x16_bf16 v[64:79], v[84:87], v[116:119], v[64:79]
    s_waitcnt vmcnt(0)
    v_mfma_f32_32x32x16_bf16 v[16:31], v[88:91], v[120:123], v[16:31]
    v_mfma_f32_32x32x16_bf16 v[32:47], v[88:91], v[124:127], v[32:47]
    v_mfma_f32_32x32x16_bf16 v[48:63], v[92:95], v[120:123], v[48:63]
    v_mfma_f32_32x32x16_bf16 v[64:79], v[92:95], v[124:127], v[64:79]
    s_setprio 3
    v_and_b32 v15, 31, v2
    s_lshl_b32 s10, s26, 6
    s_lshl_b32 s31, s9, 5
    s_add_u32 s10, s10, s31
    v_add_u32 v15, s10, v15
    v_lshlrev_b32 v129, 2, v15
    v_lshlrev_b32 v15, 1, v15
    s_mov_b32 s10, 9961472
    buffer_load_dword v112, v129, s[20:23], s10 offen sc1
    buffer_load_ushort v113, v15, s[16:19], 0 offen
    s_nop 15
    ds_write_b128 v13, v[32:35] offset:0
    ds_write_b128 v13, v[36:39] offset:1024
    ds_write_b128 v13, v[48:51] offset:2048
    ds_write_b128 v13, v[52:55] offset:3072
    ds_write_b128 v13, v[64:67] offset:4096
    ds_write_b128 v13, v[68:71] offset:5120
    s_waitcnt lgkmcnt(0)
    s_mov_b64 exec, 1
    ds_add_u32 v8, v9 offset:68
    s_mov_b64 exec, -1
    s_add_u32 s34, s34, 4
L_gated__mbar_53:
    ds_read_b32 v128, v8 offset:68
    s_waitcnt lgkmcnt(0)
    v_readfirstlane_b32 s4, v128
    s_cmp_ge_u32 s4, s34
    s_cbranch_scc1 L_gated__mbar_53d
    s_sleep 1
    s_branch L_gated__mbar_53
L_gated__mbar_53d:
    ds_read_b128 v[80:83], v10 offset:0
    ds_read_b128 v[84:87], v10 offset:1024
    ds_read_b128 v[88:91], v11 offset:2048
    ds_read_b128 v[92:95], v11 offset:3072
    ds_read_b128 v[96:99], v12 offset:4096
    ds_read_b128 v[100:103], v12 offset:5120
    s_waitcnt lgkmcnt(0)
    s_mov_b64 exec, 1
    ds_add_u32 v8, v9 offset:68
    s_mov_b64 exec, -1
    s_add_u32 s34, s34, 4
L_gated__mbar_54:
    ds_read_b32 v128, v8 offset:68
    s_waitcnt lgkmcnt(0)
    v_readfirstlane_b32 s4, v128
    s_cmp_ge_u32 s4, s34
    s_cbranch_scc1 L_gated__mbar_54d
    s_sleep 1
    s_branch L_gated__mbar_54
L_gated__mbar_54d:
    v_add_f32 v80, v80, v88
    v_add_f32 v16, v16, v96
    v_add_f32 v81, v81, v89
    v_add_f32 v17, v17, v97
    v_add_f32 v82, v82, v90
    v_add_f32 v18, v18, v98
    v_add_f32 v83, v83, v91
    v_add_f32 v19, v19, v99
    v_add_f32 v84, v84, v92
    v_add_f32 v20, v20, v100
    v_add_f32 v85, v85, v93
    v_add_f32 v21, v21, v101
    v_add_f32 v86, v86, v94
    v_add_f32 v22, v22, v102
    v_add_f32 v87, v87, v95
    v_add_f32 v23, v23, v103
    v_add_f32 v16, v16, v80
    v_add_f32 v17, v17, v81
    v_add_f32 v18, v18, v82
    v_add_f32 v19, v19, v83
    v_add_f32 v20, v20, v84
    v_add_f32 v21, v21, v85
    v_add_f32 v22, v22, v86
    v_add_f32 v23, v23, v87
    ds_write_b128 v13, v[40:43] offset:0
    ds_write_b128 v13, v[44:47] offset:1024
    ds_write_b128 v13, v[56:59] offset:2048
    ds_write_b128 v13, v[60:63] offset:3072
    ds_write_b128 v13, v[72:75] offset:4096
    ds_write_b128 v13, v[76:79] offset:5120
    s_waitcnt lgkmcnt(0)
    s_mov_b64 exec, 1
    ds_add_u32 v8, v9 offset:68
    s_mov_b64 exec, -1
    s_add_u32 s34, s34, 4
L_gated__mbar_55:
    ds_read_b32 v128, v8 offset:68
    s_waitcnt lgkmcnt(0)
    v_readfirstlane_b32 s4, v128
    s_cmp_ge_u32 s4, s34
    s_cbranch_scc1 L_gated__mbar_55d
    s_sleep 1
    s_branch L_gated__mbar_55
L_gated__mbar_55d:
    ds_read_b128 v[80:83], v10 offset:0
    ds_read_b128 v[84:87], v10 offset:1024
    ds_read_b128 v[88:91], v11 offset:2048
    ds_read_b128 v[92:95], v11 offset:3072
    ds_read_b128 v[96:99], v12 offset:4096
    ds_read_b128 v[100:103], v12 offset:5120
    s_waitcnt lgkmcnt(0)
    v_add_f32 v80, v80, v88
    v_add_f32 v24, v24, v96
    v_add_f32 v81, v81, v89
    v_add_f32 v25, v25, v97
    v_add_f32 v82, v82, v90
    v_add_f32 v26, v26, v98
    v_add_f32 v83, v83, v91
    v_add_f32 v27, v27, v99
    v_add_f32 v84, v84, v92
    v_add_f32 v28, v28, v100
    v_add_f32 v85, v85, v93
    v_add_f32 v29, v29, v101
    v_add_f32 v86, v86, v94
    v_add_f32 v30, v30, v102
    v_add_f32 v87, v87, v95
    v_add_f32 v31, v31, v103
    v_add_f32 v24, v24, v80
    v_add_f32 v25, v25, v81
    v_add_f32 v26, v26, v82
    v_add_f32 v27, v27, v83
    v_add_f32 v28, v28, v84
    v_add_f32 v29, v29, v85
    v_add_f32 v30, v30, v86
    v_add_f32 v31, v31, v87
    s_mov_b32 s12, s54
    s_and_b32 s13, s55, 0xffff
    s_mov_b32 s14, 0x200000
    s_mov_b32 s15, 0x00020000
    s_waitcnt vmcnt(0)
    v_sub_f32 v114, 1.0, v112
    v_lshlrev_b32 v113, 16, v113
    v_add_f32 v16, v16, v113
    v_add_f32 v17, v17, v113
    v_add_f32 v18, v18, v113
    v_add_f32 v19, v19, v113
    v_add_f32 v20, v20, v113
    v_add_f32 v21, v21, v113
    v_add_f32 v22, v22, v113
    v_add_f32 v23, v23, v113
    v_add_f32 v24, v24, v113
    v_add_f32 v25, v25, v113
    v_add_f32 v26, v26, v113
    v_add_f32 v27, v27, v113
    v_add_f32 v28, v28, v113
    v_add_f32 v29, v29, v113
    v_add_f32 v30, v30, v113
    v_add_f32 v31, v31, v113
    v_mul_f32 v16, v16, v114
    v_mul_f32 v17, v17, v114
    v_mul_f32 v18, v18, v114
    v_mul_f32 v19, v19, v114
    v_mul_f32 v20, v20, v114
    v_mul_f32 v21, v21, v114
    v_mul_f32 v22, v22, v114
    v_mul_f32 v23, v23, v114
    v_mul_f32 v24, v24, v114
    v_mul_f32 v25, v25, v114
    v_mul_f32 v26, v26, v114
    v_mul_f32 v27, v27, v114
    v_mul_f32 v28, v28, v114
    v_mul_f32 v29, v29, v114
    v_mul_f32 v30, v30, v114
    v_mul_f32 v31, v31, v114
    v_bfe_u32 v128, v2, 2, 2
    v_lshrrev_b32 v5, 5, v2
    v_lshl_add_u32 v5, v5, 2, v128
    v_lshlrev_b32 v5, 7, v5
    v_bfe_u32 v129, v2, 4, 1
    v_lshl_add_u32 v5, v129, 5, v5
    v_and_b32 v129, 3, v2
    v_lshl_add_u32 v5, v129, 3, v5
    v_lshrrev_b32 v129, 1, v128
    v_lshl_add_u32 v5, v129, 6, v5
    s_lshl_b32 s31, s8, 6
    v_xor_b32 v5, s31, v5
    v_add_u32 v5, 8192, v5
    s_lshl_b32 s31, s9, 10
    v_add_u32 v4, s31, v14
    v_and_b32 v10, 31, v2
    v_lshlrev_b32 v10, 10, v10
    v_lshrrev_b32 v11, 5, v2
    v_lshl_add_u32 v10, v11, 4, v10
    s_lshl_b32 s28, s26, 16
    s_lshl_b32 s31, s9, 15
    s_add_u32 s28, s28, s31
    s_lshl_b32 s31, s27, 7
    s_add_u32 s28, s28, s31
    s_lshl_b32 s31, s8, 6
    s_add_u32 s28, s28, s31
    s_mov_b32 s29, 0
    s_setprio 0
L_gated__lw_56:
    ds_read_b32 v128, v8 offset:96
    s_waitcnt lgkmcnt(0)
    v_readfirstlane_b32 s4, v128
    s_cmp_ge_u32 s4, 1
    s_cbranch_scc1 L_gated__lwd_57
    s_sleep 2
    s_branch L_gated__lw_56
L_gated__lwd_57:
    s_setprio 3
    v_add_u32 v6, 65536, v4
    v_add_u32 v7, 65536, v5
L_f_loop:
    ds_read_b32 v128, v8 offset:96
    s_waitcnt lgkmcnt(0)
    v_readfirstlane_b32 s4, v128
    s_lshr_b32 s5, s4, 1
    s_and_b32 s4, s4, s5
    s_and_b32 s4, s4, 0x55
    s_andn2_b32 s5, s4, s29
    s_bitcmp1_b32 s5, 0
    s_cbranch_scc0 L_f_s0
    s_bitset1_b32 s29, 0
    ds_read_b128 v[96:99], v4 offset:0
    ds_read_b64_tr_b16 v[136:137], v5 offset:0
    ds_read_b64_tr_b16 v[138:139], v5 offset:1024
    ds_read_b128 v[100:103], v4 offset:2048
    ds_read_b64_tr_b16 v[140:141], v5 offset:2048
    ds_read_b64_tr_b16 v[142:143], v5 offset:3072
    ds_read_b128 v[104:107], v4 offset:4096
    ds_read_b64_tr_b16 v[144:145], v5 offset:4096
    ds_read_b64_tr_b16 v[146:147], v5 offset:5120
    ds_read_b128 v[108:111], v4 offset:6144
    ds_read_b64_tr_b16 v[148:149], v5 offset:6144
    ds_read_b64_tr_b16 v[150:151], v5 offset:7168
    s_waitcnt lgkmcnt(9)
    v_mfma_f32_32x32x16_bf16 v[32:47], v[136:139], v[96:99], 0
    ds_read_b128 v[96:99], v4 offset:16384
    ds_read_b64_tr_b16 v[136:137], v5 offset:16384
    ds_read_b64_tr_b16 v[138:139], v5 offset:17408
    s_waitcnt lgkmcnt(9)
    v_mfma_f32_32x32x16_bf16 v[32:47], v[140:143], v[100:103], v[32:47]
    ds_read_b128 v[100:103], v4 offset:18432
    ds_read_b64_tr_b16 v[140:141], v5 offset:18432
    ds_read_b64_tr_b16 v[142:143], v5 offset:19456
    s_waitcnt lgkmcnt(9)
    v_mfma_f32_32x32x16_bf16 v[32:47], v[144:147], v[104:107], v[32:47]
    ds_read_b128 v[104:107], v4 offset:20480
    ds_read_b64_tr_b16 v[144:145], v5 offset:20480
    ds_read_b64_tr_b16 v[146:147], v5 offset:21504
    s_waitcnt lgkmcnt(9)
    v_mfma_f32_32x32x16_bf16 v[32:47], v[148:151], v[108:111], v[32:47]
    ds_read_b128 v[108:111], v4 offset:22528
    ds_read_b64_tr_b16 v[148:149], v5 offset:22528
    ds_read_b64_tr_b16 v[150:151], v5 offset:23552
    s_waitcnt lgkmcnt(9)
    v_mfma_f32_32x32x16_bf16 v[32:47], v[136:139], v[96:99], v[32:47]
    s_waitcnt lgkmcnt(6)
    v_mfma_f32_32x32x16_bf16 v[32:47], v[140:143], v[100:103], v[32:47]
    s_waitcnt lgkmcnt(3)
    v_mfma_f32_32x32x16_bf16 v[32:47], v[144:147], v[104:107], v[32:47]
    s_waitcnt lgkmcnt(0)
    v_mfma_f32_32x32x16_bf16 v[32:47], v[148:151], v[108:111], v[32:47]
L_f_s0:
    s_andn2_b32 s5, s4, s29
    s_bitcmp1_b32 s5, 2
    s_cbranch_scc0 L_f_s1
    s_bitset1_b32 s29, 2
    ds_read_b128 v[96:99], v4 offset:32768
    ds_read_b64_tr_b16 v[136:137], v5 offset:32768
    ds_read_b64_tr_b16 v[138:139], v5 offset:33792
    ds_read_b128 v[100:103], v4 offset:34816
    ds_read_b64_tr_b16 v[140:141], v5 offset:34816
    ds_read_b64_tr_b16 v[142:143], v5 offset:35840
    ds_read_b128 v[104:107], v4 offset:36864
    ds_read_b64_tr_b16 v[144:145], v5 offset:36864
    ds_read_b64_tr_b16 v[146:147], v5 offset:37888
    ds_read_b128 v[108:111], v4 offset:38912
    ds_read_b64_tr_b16 v[148:149], v5 offset:38912
    ds_read_b64_tr_b16 v[150:151], v5 offset:39936
    s_waitcnt lgkmcnt(9)
    v_mfma_f32_32x32x16_bf16 v[48:63], v[136:139], v[96:99], 0
    ds_read_b128 v[96:99], v4 offset:49152
    ds_read_b64_tr_b16 v[136:137], v5 offset:49152
    ds_read_b64_tr_b16 v[138:139], v5 offset:50176
    s_waitcnt lgkmcnt(9)
    v_mfma_f32_32x32x16_bf16 v[48:63], v[140:143], v[100:103], v[48:63]
    ds_read_b128 v[100:103], v4 offset:51200
    ds_read_b64_tr_b16 v[140:141], v5 offset:51200
    ds_read_b64_tr_b16 v[142:143], v5 offset:52224
    s_waitcnt lgkmcnt(9)
    v_mfma_f32_32x32x16_bf16 v[48:63], v[144:147], v[104:107], v[48:63]
    ds_read_b128 v[104:107], v4 offset:53248
    ds_read_b64_tr_b16 v[144:145], v5 offset:53248
    ds_read_b64_tr_b16 v[146:147], v5 offset:54272
    s_waitcnt lgkmcnt(9)
    v_mfma_f32_32x32x16_bf16 v[48:63], v[148:151], v[108:111], v[48:63]
    ds_read_b128 v[108:111], v4 offset:55296
    ds_read_b64_tr_b16 v[148:149], v5 offset:55296
    ds_read_b64_tr_b16 v[150:151], v5 offset:56320
    s_waitcnt lgkmcnt(9)
    v_mfma_f32_32x32x16_bf16 v[48:63], v[136:139], v[96:99], v[48:63]
    s_waitcnt lgkmcnt(6)
    v_mfma_f32_32x32x16_bf16 v[48:63], v[140:143], v[100:103], v[48:63]
    s_waitcnt lgkmcnt(3)
    v_mfma_f32_32x32x16_bf16 v[48:63], v[144:147], v[104:107], v[48:63]
    s_waitcnt lgkmcnt(0)
    v_mfma_f32_32x32x16_bf16 v[48:63], v[148:151], v[108:111], v[48:63]
L_f_s1:
    s_andn2_b32 s5, s4, s29
    s_bitcmp1_b32 s5, 4
    s_cbranch_scc0 L_f_s2
    s_bitset1_b32 s29, 4
    ds_read_b128 v[96:99], v6 offset:0
    ds_read_b64_tr_b16 v[136:137], v7 offset:0
    ds_read_b64_tr_b16 v[138:139], v7 offset:1024
    ds_read_b128 v[100:103], v6 offset:2048
    ds_read_b64_tr_b16 v[140:141], v7 offset:2048
    ds_read_b64_tr_b16 v[142:143], v7 offset:3072
    ds_read_b128 v[104:107], v6 offset:4096
    ds_read_b64_tr_b16 v[144:145], v7 offset:4096
    ds_read_b64_tr_b16 v[146:147], v7 offset:5120
    ds_read_b128 v[108:111], v6 offset:6144
    ds_read_b64_tr_b16 v[148:149], v7 offset:6144
    ds_read_b64_tr_b16 v[150:151], v7 offset:7168
    s_waitcnt lgkmcnt(9)
    v_mfma_f32_32x32x16_bf16 v[64:79], v[136:139], v[96:99], 0
    ds_read_b128 v[96:99], v6 offset:16384
    ds_read_b64_tr_b16 v[136:137], v7 offset:16384
    ds_read_b64_tr_b16 v[138:139], v7 offset:17408
    s_waitcnt lgkmcnt(9)
    v_mfma_f32_32x32x16_bf16 v[64:79], v[140:143], v[100:103], v[64:79]
    ds_read_b128 v[100:103], v6 offset:18432
    ds_read_b64_tr_b16 v[140:141], v7 offset:18432
    ds_read_b64_tr_b16 v[142:143], v7 offset:19456
    s_waitcnt lgkmcnt(9)
    v_mfma_f32_32x32x16_bf16 v[64:79], v[144:147], v[104:107], v[64:79]
    ds_read_b128 v[104:107], v6 offset:20480
    ds_read_b64_tr_b16 v[144:145], v7 offset:20480
    ds_read_b64_tr_b16 v[146:147], v7 offset:21504
    s_waitcnt lgkmcnt(9)
    v_mfma_f32_32x32x16_bf16 v[64:79], v[148:151], v[108:111], v[64:79]
    ds_read_b128 v[108:111], v6 offset:22528
    ds_read_b64_tr_b16 v[148:149], v7 offset:22528
    ds_read_b64_tr_b16 v[150:151], v7 offset:23552
    s_waitcnt lgkmcnt(9)
    v_mfma_f32_32x32x16_bf16 v[64:79], v[136:139], v[96:99], v[64:79]
    s_waitcnt lgkmcnt(6)
    v_mfma_f32_32x32x16_bf16 v[64:79], v[140:143], v[100:103], v[64:79]
    s_waitcnt lgkmcnt(3)
    v_mfma_f32_32x32x16_bf16 v[64:79], v[144:147], v[104:107], v[64:79]
    s_waitcnt lgkmcnt(0)
    v_mfma_f32_32x32x16_bf16 v[64:79], v[148:151], v[108:111], v[64:79]
L_f_s2:
    s_andn2_b32 s5, s4, s29
    s_bitcmp1_b32 s5, 6
    s_cbranch_scc0 L_f_s3
    s_bitset1_b32 s29, 6
    ds_read_b128 v[96:99], v6 offset:32768
    ds_read_b64_tr_b16 v[136:137], v7 offset:32768
    ds_read_b64_tr_b16 v[138:139], v7 offset:33792
    ds_read_b128 v[100:103], v6 offset:34816
    ds_read_b64_tr_b16 v[140:141], v7 offset:34816
    ds_read_b64_tr_b16 v[142:143], v7 offset:35840
    ds_read_b128 v[104:107], v6 offset:36864
    ds_read_b64_tr_b16 v[144:145], v7 offset:36864
    ds_read_b64_tr_b16 v[146:147], v7 offset:37888
    ds_read_b128 v[108:111], v6 offset:38912
    ds_read_b64_tr_b16 v[148:149], v7 offset:38912
    ds_read_b64_tr_b16 v[150:151], v7 offset:39936
    s_waitcnt lgkmcnt(9)
    v_mfma_f32_32x32x16_bf16 v[80:95], v[136:139], v[96:99], 0
    ds_read_b128 v[96:99], v6 offset:49152
    ds_read_b64_tr_b16 v[136:137], v7 offset:49152
    ds_read_b64_tr_b16 v[138:139], v7 offset:50176
    s_waitcnt lgkmcnt(9)
    v_mfma_f32_32x32x16_bf16 v[80:95], v[140:143], v[100:103], v[80:95]
    ds_read_b128 v[100:103], v6 offset:51200
    ds_read_b64_tr_b16 v[140:141], v7 offset:51200
    ds_read_b64_tr_b16 v[142:143], v7 offset:52224
    s_waitcnt lgkmcnt(9)
    v_mfma_f32_32x32x16_bf16 v[80:95], v[144:147], v[104:107], v[80:95]
    ds_read_b128 v[104:107], v6 offset:53248
    ds_read_b64_tr_b16 v[144:145], v7 offset:53248
    ds_read_b64_tr_b16 v[146:147], v7 offset:54272
    s_waitcnt lgkmcnt(9)
    v_mfma_f32_32x32x16_bf16 v[80:95], v[148:151], v[108:111], v[80:95]
    ds_read_b128 v[108:111], v6 offset:55296
    ds_read_b64_tr_b16 v[148:149], v7 offset:55296
    ds_read_b64_tr_b16 v[150:151], v7 offset:56320
    s_waitcnt lgkmcnt(9)
    v_mfma_f32_32x32x16_bf16 v[80:95], v[136:139], v[96:99], v[80:95]
    s_waitcnt lgkmcnt(6)
    v_mfma_f32_32x32x16_bf16 v[80:95], v[140:143], v[100:103], v[80:95]
    s_waitcnt lgkmcnt(3)
    v_mfma_f32_32x32x16_bf16 v[80:95], v[144:147], v[104:107], v[80:95]
    s_waitcnt lgkmcnt(0)
    v_mfma_f32_32x32x16_bf16 v[80:95], v[148:151], v[108:111], v[80:95]
L_f_s3:
    s_cmp_lg_u32 s29, 0x55
    s_cbranch_scc1 L_f_loop
    s_nop 12
    v_pk_add_f32 v[32:33], v[32:33], v[48:49]
    v_pk_add_f32 v[64:65], v[64:65], v[80:81]
    v_pk_add_f32 v[34:35], v[34:35], v[50:51]
    v_pk_add_f32 v[66:67], v[66:67], v[82:83]
    v_pk_add_f32 v[36:37], v[36:37], v[52:53]
    v_pk_add_f32 v[68:69], v[68:69], v[84:85]
    v_pk_add_f32 v[38:39], v[38:39], v[54:55]
    v_pk_add_f32 v[70:71], v[70:71], v[86:87]
    v_pk_add_f32 v[40:41], v[40:41], v[56:57]
    v_pk_add_f32 v[72:73], v[72:73], v[88:89]
    v_pk_add_f32 v[42:43], v[42:43], v[58:59]
    v_pk_add_f32 v[74:75], v[74:75], v[90:91]
    v_pk_add_f32 v[44:45], v[44:45], v[60:61]
    v_pk_add_f32 v[76:77], v[76:77], v[92:93]
    v_pk_add_f32 v[46:47], v[46:47], v[62:63]
    v_pk_add_f32 v[78:79], v[78:79], v[94:95]
    v_pk_add_f32 v[32:33], v[32:33], v[64:65]
    v_pk_add_f32 v[34:35], v[34:35], v[66:67]
    v_pk_add_f32 v[36:37], v[36:37], v[68:69]
    v_pk_add_f32 v[38:39], v[38:39], v[70:71]
    v_pk_add_f32 v[40:41], v[40:41], v[72:73]
    v_pk_add_f32 v[42:43], v[42:43], v[74:75]
    v_pk_add_f32 v[44:45], v[44:45], v[76:77]
    v_pk_add_f32 v[46:47], v[46:47], v[78:79]
    v_fmac_f32 v16, v32, v112
    v_fmac_f32 v17, v33, v112
    v_fmac_f32 v18, v34, v112
    v_fmac_f32 v19, v35, v112
    v_fmac_f32 v20, v36, v112
    v_fmac_f32 v21, v37, v112
    v_fmac_f32 v22, v38, v112
    v_fmac_f32 v23, v39, v112
    v_fmac_f32 v24, v40, v112
    v_fmac_f32 v25, v41, v112
    v_fmac_f32 v26, v42, v112
    v_fmac_f32 v27, v43, v112
    v_fmac_f32 v28, v44, v112
    v_fmac_f32 v29, v45, v112
    v_fmac_f32 v30, v46, v112
    v_fmac_f32 v31, v47, v112
    v_cvt_pk_bf16_f32 v48, v16, v17
    v_cvt_pk_bf16_f32 v49, v18, v19
    v_cvt_pk_bf16_f32 v50, v20, v21
    v_cvt_pk_bf16_f32 v51, v22, v23
    v_cvt_pk_bf16_f32 v52, v24, v25
    v_cvt_pk_bf16_f32 v53, v26, v27
    v_cvt_pk_bf16_f32 v54, v28, v29
    v_cvt_pk_bf16_f32 v55, v30, v31
    s_nop 1
    v_permlane32_swap_b32 v48, v50
    v_permlane32_swap_b32 v49, v51
    v_permlane32_swap_b32 v52, v54
    v_permlane32_swap_b32 v53, v55
    s_nop 1
    buffer_store_dwordx4 v[48:51], v10, s[12:15], s28 offen
    buffer_store_dwordx4 v[52:55], v10, s[12:15], s28 offen offset:32
L_end:
    s_endpgm
.section .rodata,"a"
.p2align 6
.amdhsa_kernel gated_mix__softmax_full_mha__mixer_token_mlp__prompt_kernel
  .amdhsa_next_free_vgpr 168
  .amdhsa_next_free_sgpr 96
  .amdhsa_accum_offset 168
  .amdhsa_group_segment_fixed_size 0
  .amdhsa_kernarg_size 96
  .amdhsa_user_sgpr_count 2
  .amdhsa_user_sgpr_kernarg_segment_ptr 1
  .amdhsa_system_sgpr_workgroup_id_x 1
.end_amdhsa_kernel
```
